```python
import torch

def _softmax(x, axis=-1):
    return torch.softmax(x, dim=axis)
def _gelu(x):
    return torch.nn.functional.gelu(x, approximate="tanh")
def _silu(x):
    return torch.nn.functional.silu(x)
def _sigmoid(x):
    return torch.sigmoid(x)
def _layernorm(x, axis=-1, eps=1e-5):
    m = x.mean(dim=axis, keepdim=True)
    v = x.var(dim=axis, keepdim=True, unbiased=False)
    return (x - m) / torch.sqrt(v + eps)
def _scatter_add(tgt, idx, src, axis=0):
    return tgt.clone().index_add_(axis, idx, src)
def _segment_sum(src, seg, n):
    out = torch.zeros((n,) + src.shape[1:], dtype=src.dtype)
    return out.index_add_(0, seg, src)
def _pad(x, pw):
    flat = tuple(v for pair in reversed(pw) for v in pair)
    return torch.nn.functional.pad(x, flat)

kernel_name = 'gated_mix__sliding_local_dilated__softmax_full_mha__prompt'

def setup_inputs():

    _w = (lambda a: (lambda t: t.to(torch.bfloat16) if t.is_floating_point() else t)(torch.as_tensor(a)))
    def _A_setup():
        B, S, D = 1, 2048, 576
        return {
            "x": _w((lambda *s: torch.randn(*s, dtype=torch.bfloat16) * 0.05)(B, S, D)),
            "wqkv": _w((lambda *s: torch.randn(*s, dtype=torch.bfloat16) * 3.2)(D, 3 * D)),
            "wo": _w((lambda *s: torch.randn(*s, dtype=torch.bfloat16) * 0.1)(D, D)),
        }
    _A_in = _A_setup()

    def _B_setup():
        B, S, D = 1, 2048, 576
        return {
            "x": _w((lambda *s: torch.randn(*s, dtype=torch.bfloat16) * 0.05)(B, S, D)),
            "wqkv": _w((lambda *s: torch.randn(*s, dtype=torch.bfloat16) * 1.6)(D, 3 * D)),
            "wo": _w((lambda *s: torch.randn(*s, dtype=torch.bfloat16) * 0.2)(D, D)),
        }
    _B_in = _B_setup()

    return {
        "A_x": _A_in["x"],
        "A_wqkv": _A_in["wqkv"],
        "A_wo": _A_in["wo"],
        "B_x": _B_in["x"],
        "B_wqkv": _B_in["wqkv"],
        "B_wo": _B_in["wo"],
        "gate_w": _w((lambda *s: torch.randn(*s, dtype=torch.bfloat16) * 0.05)(576) * 16.0),
    }

def reference(A_x, A_wqkv, A_wo, B_x, B_wqkv, B_wo, gate_w):
    def _A_ref(x, wqkv, wo):
        B, S, D = x.shape
        H = 32; Dh = D // H
        W, dil = 8, 2
        qkv = (lambda x, *d: x.permute(*d))((x @ wqkv).reshape(B, S, 3, H, Dh), 2, 0, 3, 1, 4)
        q, k, v = qkv[0], qkv[1], qkv[2]
        scale = Dh ** -0.5
        pos = torch.arange(S)
        off = torch.arange(W) * dil
        idx = pos[:, None] - off[None, :]
        mask = idx >= 0
        idx_c = torch.where(mask, idx, 0).reshape(-1)
        kg = k[:, :, idx_c, :].reshape(B, H, S, W, Dh)
        vg = v[:, :, idx_c, :].reshape(B, H, S, W, Dh)
        logits = torch.einsum("bhsd,bhswd->bhsw", q, kg) * scale
        logits = torch.where(mask[None, None, :, :], logits, -1e9)
        attn = _softmax(logits, axis=-1)
        o = torch.einsum("bhsw,bhswd->bhsd", attn, vg)
        return (lambda x, *d: x.permute(*d))(o, 0, 2, 1, 3).reshape(B, S, D) @ wo

    def _B_ref(x, wqkv, wo):
        B, S, D = x.shape
        H = 32; Dh = D // H
        qkv = (lambda x, *d: x.permute(*d))((x @ wqkv).reshape(B, S, 3, H, Dh), 2, 0, 3, 1, 4)
        q, k, v = qkv[0], qkv[1], qkv[2]
        scale = Dh ** -0.5
        scores = torch.einsum("bhqd,bhkd->bhqk", q, k) * scale
        p = _softmax(scores, axis=-1)
        o = torch.einsum("bhqk,bhkd->bhqd", p, v)
        return (lambda x, *d: x.permute(*d))(o, 0, 2, 1, 3).reshape(B, S, D) @ wo

    x = A_x
    g = _sigmoid((x * gate_w).sum(-1, keepdims=True))
    a = _A_ref(x, A_wqkv, A_wo)
    b = _B_ref(x, B_wqkv, B_wo)
    return g * a + (1 - g) * b
```

```asm
; @launch kernel=f3_kernel grid=(256,1,1) block=(768,1,1) lds=163840
.amdgcn_target "amdgcn-amd-amdhsa--gfx950"
.text
.globl f3_kernel
.p2align 8
.type f3_kernel,@function
f3_kernel:
    s_cmp_ge_u32 s2, 256
    s_cbranch_scc1 L_f3_kernel_end
    s_load_dwordx2 s[4:5], s[0:1], 0
    s_load_dwordx2 s[8:9], s[0:1], 8
    s_load_dwordx2 s[48:49], s[0:1], 32
    s_load_dwordx2 s[12:13], s[0:1], 72
    s_load_dwordx2 s[16:17], s[0:1], 48
    s_load_dwordx2 s[50:51], s[0:1], 16
    s_load_dwordx2 s[52:53], s[0:1], 40
    s_load_dwordx2 s[54:55], s[0:1], 64
    s_load_dwordx2 s[92:93], s[0:1], 56
    s_memrealtime s[14:15]
    s_getpc_b64 s[30:31]
L_f3_kernel_pc:
    v_cmp_gt_u32 vcc, 12, v0
    s_and_saveexec_b64 s[32:33], vcc
    s_cbranch_execz L_f3_kernel_nopf
    s_lshr_b32 s28, s2, 3
    s_mul_i32 s28, s28, 12
    v_add_u32 v1, s28, v0
    v_lshlrev_b32 v1, 7, v1
    v_min_u32 v1, L_f3_kernel_end-L_f3_kernel_pc, v1
    v_mov_b32 v3, s31
    v_add_co_u32 v2, vcc, s30, v1
    s_nop 1
    v_addc_co_u32 v3, vcc, 0, v3, vcc
    global_load_dword v15, v[2:3], off
L_f3_kernel_nopf:
    s_mov_b64 exec, s[32:33]
    v_lshrrev_b32 v1, 6, v0
    v_and_b32 v0, 63, v0
    s_and_b32 s26, s2, 7
    v_readfirstlane_b32 s20, v1
    s_lshr_b32 s27, s2, 3
    s_lshr_b32 s28, s26, 2
    s_lshl_b32 s28, s28, 2
    s_and_b32 s29, s27, 3
    s_add_u32 s22, s28, s29
    s_and_b32 s28, s26, 3
    s_lshl_b32 s28, s28, 3
    s_lshr_b32 s29, s27, 2
    s_add_u32 s21, s28, s29
    s_cmp_lt_u32 s20, 8
    s_cbranch_scc1 L_f3_kernel_compute
    s_cmp_ge_u32 s20, 10
    s_cbranch_scc1 L_f3_kernel_helper
    s_setprio 1
    s_sub_u32 s25, s20, 8
    v_lshrrev_b32 v1, 3, v0
    v_lshrrev_b32 v2, 4, v0
    v_xor_b32 v3, v0, v2
    s_lshl_b32 s26, s25, 2
    v_xor_b32 v3, s26, v3
    v_mul_u32_u24 v1, 1152, v1
    v_and_b32 v3, 7, v3
    s_lshl_b32 s27, s22, 8
    s_mul_i32 s28, s25, 136
    v_lshl_add_u32 v10, v3, 4, v1
    v_xor_b32 v3, 4, v3
    v_add_u32 v1, 9216, v1
    s_add_u32 s27, s27, s28
    v_lshl_add_u32 v11, v3, 4, v1
    s_mul_i32 s35, s27, 1152
    s_sub_u32 s34, s35, 18432
    s_cmp_eq_u32 s27, 0
    s_cselect_b32 s34, 0, s34
    s_mul_i32 s41, s25, 17408
    s_mul_i32 s42, s25, 9248
    s_add_u32 s42, s42, 34816
    s_lshr_b32 s26, s21, 1
    s_mul_i32 s36, s26, 72
    s_and_b32 s26, s26, 1
    s_lshl_b32 s26, s26, 3
    s_sub_u32 s36, s36, s26
    s_and_b32 s26, s21, 1
    s_lshl_b32 s26, s26, 5
    s_add_u32 s36, s36, s26
    s_mov_b32 s37, 0
    s_mov_b32 s38, 0
    s_mov_b32 s45, 221184
    s_movk_i32 s46, 1152
    s_waitcnt lgkmcnt(0)
    s_mov_b32 s6, 2359296
    s_mov_b32 s7, 0x00020000
    s_cmp_eq_u32 s25, 0
    s_cselect_b32 s8, s8, s48
    s_cselect_b32 s9, s9, s49
    s_mov_b32 s10, 1990656
    s_mov_b32 s11, 0x00020000
    s_mov_b32 s14, 20733952
    s_mov_b32 s15, 0x00020000
    s_lshl_b32 s33, s21, 9
    s_add_u32 s33, s33, 12288
    s_lshl_b32 s26, s25, 8
    s_add_u32 s33, s33, s26
    v_lshlrev_b32 v15, 2, v0
    s_and_b32 s26, s21, 7
    s_mul_i32 s26, s26, 34
    s_mul_i32 s27, s25, 17
    s_add_u32 s26, s26, s27
    s_lshl_b32 s27, s22, 8
    s_add_u32 s26, s26, s27
    s_sub_u32 s26, s26, 16
    s_movk_i32 s27, 1152
    v_mul_u32_u24 v2, 241, v0
    v_lshrrev_b32 v2, 12, v2
    v_min_u32 v2, 2, v2
    v_mul_u32_u24 v3, 17, v2
    v_sub_u32 v3, v0, v3
    v_min_u32 v3, 16, v3
    v_add_u32 v3, s26, v3
    v_max_i32 v3, 0, v3
    v_mul_lo_u32 v3, v3, s27
    v_lshl_add_u32 v31, v2, 7, v3
    s_mov_b32 s90, 0
    s_mov_b32 s91, 0
    s_mov_b32 s94, 0
    s_barrier
    v_mov_b32 v6, 160128
    s_barrier
    ds_read_b32 v6, v6
    s_waitcnt lgkmcnt(0)
    v_readfirstlane_b32 s44, v6
    s_movk_i32 s26, 3456
    s_movk_i32 s28, 21846
    s_add_u32 s39, 0, s42
    v_add_u32 v1, 0, v0
    v_mul_u32_u24 v2, s28, v1
    v_lshrrev_b32 v2, 16, v2
    v_mul_u32_u24 v3, 3, v2
    v_sub_u32 v3, v1, v3
    v_and_b32 v4, 15, v2
    v_mul_u32_u24 v4, 17, v4
    v_bfe_u32 v4, v4, 2, 4
    v_and_or_b32 v2, v2, 48, v4
    v_lshlrev_b32 v3, 4, v3
    v_mad_u32_u24 v12, v2, s26, v3
    s_add_u32 m0, s39, 0
    s_nop 0
    buffer_load_dwordx4 v12, s[8:11], s36 offen sc1 lds
    v_add_u32 v1, 64, v0
    v_mul_u32_u24 v2, s28, v1
    v_lshrrev_b32 v2, 16, v2
    v_mul_u32_u24 v3, 3, v2
    v_sub_u32 v3, v1, v3
    v_and_b32 v4, 15, v2
    v_mul_u32_u24 v4, 17, v4
    v_bfe_u32 v4, v4, 2, 4
    v_and_or_b32 v2, v2, 48, v4
    v_lshlrev_b32 v3, 4, v3
    v_mad_u32_u24 v13, v2, s26, v3
    s_add_u32 m0, s39, 1024
    s_nop 0
    buffer_load_dwordx4 v13, s[8:11], s36 offen sc1 lds
    v_add_u32 v1, 128, v0
    v_mul_u32_u24 v2, s28, v1
    v_lshrrev_b32 v2, 16, v2
    v_mul_u32_u24 v3, 3, v2
    v_sub_u32 v3, v1, v3
    v_and_b32 v4, 15, v2
    v_mul_u32_u24 v4, 17, v4
    v_bfe_u32 v4, v4, 2, 4
    v_and_or_b32 v2, v2, 48, v4
    v_lshlrev_b32 v3, 4, v3
    v_mad_u32_u24 v14, v2, s26, v3
    s_add_u32 m0, s39, 2048
    s_nop 0
    buffer_load_dwordx4 v14, s[8:11], s36 offen sc1 lds
    s_add_u32 s40, s36, s46
    s_add_u32 m0, s39, 3088
    s_nop 0
    buffer_load_dwordx4 v12, s[8:11], s40 offen sc1 lds
    s_add_u32 m0, s39, 4112
    s_nop 0
    buffer_load_dwordx4 v13, s[8:11], s40 offen sc1 lds
    s_add_u32 m0, s39, 5136
    s_nop 0
    buffer_load_dwordx4 v14, s[8:11], s40 offen sc1 lds
    s_add_u32 s40, s40, s46
    s_add_u32 m0, s39, 6176
    s_nop 0
    buffer_load_dwordx4 v12, s[8:11], s40 offen sc1 lds
    s_add_u32 m0, s39, 7200
    s_nop 0
    buffer_load_dwordx4 v13, s[8:11], s40 offen sc1 lds
    s_add_u32 m0, s39, 8224
    s_nop 0
    buffer_load_dwordx4 v14, s[8:11], s40 offen sc1 lds
    s_add_u32 s36, s36, s45
    s_add_u32 s39, s38, s41
    s_add_u32 m0, s39, 0
    s_nop 0
    buffer_load_dwordx4 v10, s[4:7], s34 offen  lds
    s_add_u32 m0, s39, 1024
    s_nop 0
    buffer_load_dwordx4 v11, s[4:7], s34 offen  lds
    s_add_u32 m0, s39, 2048
    s_mov_b32 s40, s35
    buffer_load_dwordx4 v10, s[4:7], s40 offen  lds
    s_add_u32 m0, s39, 3072
    s_nop 0
    buffer_load_dwordx4 v11, s[4:7], s40 offen  lds
    s_add_u32 m0, s39, 4096
    s_add_u32 s40, s40, 18432
    buffer_load_dwordx4 v10, s[4:7], s40 offen  lds
    s_add_u32 m0, s39, 5120
    s_nop 0
    buffer_load_dwordx4 v11, s[4:7], s40 offen  lds
    s_add_u32 m0, s39, 6144
    s_add_u32 s40, s40, 18432
    buffer_load_dwordx4 v10, s[4:7], s40 offen  lds
    s_add_u32 m0, s39, 7168
    s_nop 0
    buffer_load_dwordx4 v11, s[4:7], s40 offen  lds
    s_add_u32 m0, s39, 8192
    s_add_u32 s40, s40, 18432
    buffer_load_dwordx4 v10, s[4:7], s40 offen  lds
    s_add_u32 m0, s39, 9216
    s_nop 0
    buffer_load_dwordx4 v11, s[4:7], s40 offen  lds
    s_add_u32 m0, s39, 10240
    s_add_u32 s40, s40, 18432
    buffer_load_dwordx4 v10, s[4:7], s40 offen  lds
    s_add_u32 m0, s39, 11264
    s_nop 0
    buffer_load_dwordx4 v11, s[4:7], s40 offen  lds
    s_add_u32 m0, s39, 12288
    s_add_u32 s40, s40, 18432
    buffer_load_dwordx4 v10, s[4:7], s40 offen  lds
    s_add_u32 m0, s39, 13312
    s_nop 0
    buffer_load_dwordx4 v11, s[4:7], s40 offen  lds
    s_add_u32 m0, s39, 14336
    s_add_u32 s40, s40, 18432
    buffer_load_dwordx4 v10, s[4:7], s40 offen  lds
    s_add_u32 m0, s39, 15360
    s_nop 0
    buffer_load_dwordx4 v11, s[4:7], s40 offen  lds
    s_add_u32 m0, s39, 16384
    s_add_u32 s40, s40, 18432
    buffer_load_dwordx4 v10, s[4:7], s40 offen  lds
    s_add_u32 s34, s34, 128
    s_add_u32 s35, s35, 128
    s_add_u32 s38, s38, 53376
    buffer_load_dword v30, v31, s[4:7], 0 offen offset:256
    s_waitcnt vmcnt(1)
    s_barrier
    s_add_u32 s39, s38, s41
    s_add_u32 m0, s39, 0
    s_nop 0
    buffer_load_dwordx4 v10, s[4:7], s34 offen  lds
    s_add_u32 m0, s39, 1024
    s_nop 0
    buffer_load_dwordx4 v11, s[4:7], s34 offen  lds
    s_add_u32 m0, s39, 2048
    s_mov_b32 s40, s35
    buffer_load_dwordx4 v10, s[4:7], s40 offen  lds
    s_add_u32 m0, s39, 3072
    s_nop 0
    buffer_load_dwordx4 v11, s[4:7], s40 offen  lds
    s_add_u32 m0, s39, 4096
    s_add_u32 s40, s40, 18432
    buffer_load_dwordx4 v10, s[4:7], s40 offen  lds
    s_add_u32 m0, s39, 5120
    s_nop 0
    buffer_load_dwordx4 v11, s[4:7], s40 offen  lds
    s_add_u32 m0, s39, 6144
    s_add_u32 s40, s40, 18432
    buffer_load_dwordx4 v10, s[4:7], s40 offen  lds
    s_add_u32 m0, s39, 7168
    s_nop 0
    buffer_load_dwordx4 v11, s[4:7], s40 offen  lds
    s_add_u32 m0, s39, 8192
    s_add_u32 s40, s40, 18432
    buffer_load_dwordx4 v10, s[4:7], s40 offen  lds
    s_add_u32 m0, s39, 9216
    s_nop 0
    buffer_load_dwordx4 v11, s[4:7], s40 offen  lds
    s_add_u32 m0, s39, 10240
    s_add_u32 s40, s40, 18432
    buffer_load_dwordx4 v10, s[4:7], s40 offen  lds
    s_add_u32 m0, s39, 11264
    s_nop 0
    buffer_load_dwordx4 v11, s[4:7], s40 offen  lds
    s_add_u32 m0, s39, 12288
    s_add_u32 s40, s40, 18432
    buffer_load_dwordx4 v10, s[4:7], s40 offen  lds
    s_add_u32 m0, s39, 13312
    s_nop 0
    buffer_load_dwordx4 v11, s[4:7], s40 offen  lds
    s_add_u32 m0, s39, 14336
    s_add_u32 s40, s40, 18432
    buffer_load_dwordx4 v10, s[4:7], s40 offen  lds
    s_add_u32 m0, s39, 15360
    s_nop 0
    buffer_load_dwordx4 v11, s[4:7], s40 offen  lds
    s_add_u32 m0, s39, 16384
    s_add_u32 s40, s40, 18432
    buffer_load_dwordx4 v10, s[4:7], s40 offen  lds
    s_add_u32 s34, s34, 128
    s_add_u32 s35, s35, 128
    s_add_u32 s38, s38, 53376
    s_movk_i32 s26, 3456
    s_movk_i32 s28, 21846
    s_add_u32 s39, 53376, s42
    s_add_u32 m0, s39, 0
    s_nop 0
    buffer_load_dwordx4 v12, s[8:11], s36 offen sc1 lds
    s_add_u32 m0, s39, 1024
    s_nop 0
    buffer_load_dwordx4 v13, s[8:11], s36 offen sc1 lds
    s_add_u32 m0, s39, 2048
    s_nop 0
    buffer_load_dwordx4 v14, s[8:11], s36 offen sc1 lds
    s_add_u32 s40, s36, s46
    s_add_u32 m0, s39, 3088
    s_nop 0
    buffer_load_dwordx4 v12, s[8:11], s40 offen sc1 lds
    s_add_u32 m0, s39, 4112
    s_nop 0
    buffer_load_dwordx4 v13, s[8:11], s40 offen sc1 lds
    s_add_u32 m0, s39, 5136
    s_nop 0
    buffer_load_dwordx4 v14, s[8:11], s40 offen sc1 lds
    s_add_u32 s40, s40, s46
    s_add_u32 m0, s39, 6176
    s_nop 0
    buffer_load_dwordx4 v12, s[8:11], s40 offen sc1 lds
    s_add_u32 m0, s39, 7200
    s_nop 0
    buffer_load_dwordx4 v13, s[8:11], s40 offen sc1 lds
    s_add_u32 m0, s39, 8224
    s_nop 0
    buffer_load_dwordx4 v14, s[8:11], s40 offen sc1 lds
    s_mul_i32 s36, s21, 129024
    s_mul_i32 s26, s25, 9216
    s_add_u32 s36, s36, s26
    s_add_u32 s36, s36, 7348224
    s_mov_b32 s8, s12
    s_mov_b32 s9, s13
    s_mov_b32 s10, 20733952
    s_movk_i32 s45, 18432
    s_movk_i32 s46, 3072
    v_lshlrev_b32 v12, 4, v0
    v_add_u32 v13, 1024, v12
    v_add_u32 v14, 2048, v12
    buffer_load_dword v7, v15, s[12:15], s33 offen sc1
    s_add_u32 s39, s38, s41
    s_add_u32 m0, s39, 0
    s_nop 0
    buffer_load_dwordx4 v10, s[4:7], s34 offen  lds
    s_add_u32 m0, s39, 1024
    s_nop 0
    buffer_load_dwordx4 v11, s[4:7], s34 offen  lds
    s_add_u32 m0, s39, 2048
    s_mov_b32 s40, s35
    buffer_load_dwordx4 v10, s[4:7], s40 offen  lds
    s_add_u32 m0, s39, 3072
    s_nop 0
    buffer_load_dwordx4 v11, s[4:7], s40 offen  lds
    s_add_u32 m0, s39, 4096
    s_add_u32 s40, s40, 18432
    buffer_load_dwordx4 v10, s[4:7], s40 offen  lds
    s_add_u32 m0, s39, 5120
    s_nop 0
    buffer_load_dwordx4 v11, s[4:7], s40 offen  lds
    s_add_u32 m0, s39, 6144
    s_add_u32 s40, s40, 18432
    buffer_load_dwordx4 v10, s[4:7], s40 offen  lds
    s_add_u32 m0, s39, 7168
    s_nop 0
    buffer_load_dwordx4 v11, s[4:7], s40 offen  lds
    s_add_u32 m0, s39, 8192
    s_add_u32 s40, s40, 18432
    buffer_load_dwordx4 v10, s[4:7], s40 offen  lds
    s_add_u32 m0, s39, 9216
    s_nop 0
    buffer_load_dwordx4 v11, s[4:7], s40 offen  lds
    s_add_u32 m0, s39, 10240
    s_add_u32 s40, s40, 18432
    buffer_load_dwordx4 v10, s[4:7], s40 offen  lds
    s_add_u32 m0, s39, 11264
    s_nop 0
    buffer_load_dwordx4 v11, s[4:7], s40 offen  lds
    s_add_u32 m0, s39, 12288
    s_add_u32 s40, s40, 18432
    buffer_load_dwordx4 v10, s[4:7], s40 offen  lds
    s_add_u32 m0, s39, 13312
    s_nop 0
    buffer_load_dwordx4 v11, s[4:7], s40 offen  lds
    s_add_u32 m0, s39, 14336
    s_add_u32 s40, s40, 18432
    buffer_load_dwordx4 v10, s[4:7], s40 offen  lds
    s_add_u32 m0, s39, 15360
    s_nop 0
    buffer_load_dwordx4 v11, s[4:7], s40 offen  lds
    s_add_u32 m0, s39, 16384
    s_add_u32 s40, s40, 18432
    buffer_load_dwordx4 v10, s[4:7], s40 offen  lds
    s_add_u32 s34, s34, 128
    s_add_u32 s35, s35, 128
    s_add_u32 s38, s38, 53376
    s_waitcnt vmcnt(18)
    s_barrier
    s_waitcnt vmcnt(17)
    v_cmp_eq_u32 vcc, s44, v7
    s_or_b64 s[90:91], s[90:91], vcc
L_pl_2:
    s_and_b32 s30, s90, 0xffffffff
    s_and_b32 s31, s91, 0xffffff
    s_xor_b32 s30, s30, 0xffffffff
    s_xor_b32 s31, s31, 0xffffff
    s_or_b32 s30, s30, s31
    s_cmp_eq_u32 s30, 0
    s_cbranch_scc1 L_pd_3
    buffer_load_dword v7, v15, s[12:15], s33 offen sc1
    s_add_u32 s94, s94, 1
    s_cmp_ge_u32 s94, 65536
    s_cbranch_scc1 L_pd_3
    s_waitcnt vmcnt(0)
    v_cmp_eq_u32 s[90:91], s44, v7
    s_branch L_pl_2
L_pd_3:
    s_add_u32 s39, 106752, s42
    s_add_u32 m0, s39, 0
    s_nop 0
    buffer_load_dwordx4 v12, s[8:11], s36 offen sc1 lds
    s_add_u32 m0, s39, 1024
    s_nop 0
    buffer_load_dwordx4 v13, s[8:11], s36 offen sc1 lds
    s_add_u32 m0, s39, 2048
    s_nop 0
    buffer_load_dwordx4 v14, s[8:11], s36 offen sc1 lds
    s_add_u32 s40, s36, s46
    s_add_u32 m0, s39, 3088
    s_nop 0
    buffer_load_dwordx4 v12, s[8:11], s40 offen sc1 lds
    s_add_u32 m0, s39, 4112
    s_nop 0
    buffer_load_dwordx4 v13, s[8:11], s40 offen sc1 lds
    s_add_u32 m0, s39, 5136
    s_nop 0
    buffer_load_dwordx4 v14, s[8:11], s40 offen sc1 lds
    s_add_u32 s40, s40, s46
    s_add_u32 m0, s39, 6176
    s_nop 0
    buffer_load_dwordx4 v12, s[8:11], s40 offen sc1 lds
    s_add_u32 m0, s39, 7200
    s_nop 0
    buffer_load_dwordx4 v13, s[8:11], s40 offen sc1 lds
    s_add_u32 m0, s39, 8224
    s_nop 0
    buffer_load_dwordx4 v14, s[8:11], s40 offen sc1 lds
    s_add_u32 s36, s36, 18432
    s_mov_b32 s38, 0
    s_mov_b32 s37, 3
    s_mov_b32 s92, 0xffffffff
    s_mov_b32 s93, 0xffffff
    s_branch L_l3_1
L_f3_kernel_ldloop:
    s_waitcnt vmcnt(26)
    s_barrier
L_l3_1:
    s_add_u32 s39, s38, s41
    s_add_u32 m0, s39, 0
    s_nop 0
    buffer_load_dwordx4 v10, s[4:7], s34 offen  lds
    s_add_u32 m0, s39, 1024
    s_nop 0
    buffer_load_dwordx4 v11, s[4:7], s34 offen  lds
    s_add_u32 m0, s39, 2048
    s_mov_b32 s40, s35
    buffer_load_dwordx4 v10, s[4:7], s40 offen  lds
    s_add_u32 m0, s39, 3072
    s_nop 0
    buffer_load_dwordx4 v11, s[4:7], s40 offen  lds
    s_add_u32 m0, s39, 4096
    s_add_u32 s40, s40, 18432
    buffer_load_dwordx4 v10, s[4:7], s40 offen  lds
    s_add_u32 m0, s39, 5120
    s_nop 0
    buffer_load_dwordx4 v11, s[4:7], s40 offen  lds
    s_add_u32 m0, s39, 6144
    s_add_u32 s40, s40, 18432
    buffer_load_dwordx4 v10, s[4:7], s40 offen  lds
    s_add_u32 m0, s39, 7168
    s_nop 0
    buffer_load_dwordx4 v11, s[4:7], s40 offen  lds
    s_add_u32 m0, s39, 8192
    s_add_u32 s40, s40, 18432
    buffer_load_dwordx4 v10, s[4:7], s40 offen  lds
    s_add_u32 m0, s39, 9216
    s_nop 0
    buffer_load_dwordx4 v11, s[4:7], s40 offen  lds
    s_add_u32 m0, s39, 10240
    s_add_u32 s40, s40, 18432
    buffer_load_dwordx4 v10, s[4:7], s40 offen  lds
    s_add_u32 m0, s39, 11264
    s_nop 0
    buffer_load_dwordx4 v11, s[4:7], s40 offen  lds
    s_add_u32 m0, s39, 12288
    s_add_u32 s40, s40, 18432
    buffer_load_dwordx4 v10, s[4:7], s40 offen  lds
    s_add_u32 m0, s39, 13312
    s_nop 0
    buffer_load_dwordx4 v11, s[4:7], s40 offen  lds
    s_add_u32 m0, s39, 14336
    s_add_u32 s40, s40, 18432
    buffer_load_dwordx4 v10, s[4:7], s40 offen  lds
    s_add_u32 m0, s39, 15360
    s_nop 0
    buffer_load_dwordx4 v11, s[4:7], s40 offen  lds
    s_add_u32 m0, s39, 16384
    s_add_u32 s40, s40, 18432
    buffer_load_dwordx4 v10, s[4:7], s40 offen  lds
L_pl_4:
    s_and_b32 s30, s90, s92
    s_and_b32 s31, s91, s93
    s_xor_b32 s30, s30, s92
    s_xor_b32 s31, s31, s93
    s_or_b32 s30, s30, s31
    s_cmp_eq_u32 s30, 0
    s_cbranch_scc1 L_pd_5
    buffer_load_dword v7, v15, s[12:15], s33 offen sc1
    s_add_u32 s94, s94, 1
    s_cmp_ge_u32 s94, 65536
    s_cbranch_scc1 L_pd_5
    s_waitcnt vmcnt(0)
    v_cmp_eq_u32 s[90:91], s44, v7
    s_branch L_pl_4
L_pd_5:
    s_mov_b32 s92, 0xffffffff
    s_mov_b32 s93, 0xffffff
    s_add_u32 s39, s38, s42
    s_add_u32 m0, s39, 0
    s_nop 0
    buffer_load_dwordx4 v12, s[8:11], s36 offen sc1 lds
    s_add_u32 m0, s39, 1024
    s_nop 0
    buffer_load_dwordx4 v13, s[8:11], s36 offen sc1 lds
    s_add_u32 m0, s39, 2048
    s_nop 0
    buffer_load_dwordx4 v14, s[8:11], s36 offen sc1 lds
    s_add_u32 s40, s36, s46
    s_add_u32 m0, s39, 3088
    s_nop 0
    buffer_load_dwordx4 v12, s[8:11], s40 offen sc1 lds
    s_add_u32 m0, s39, 4112
    s_nop 0
    buffer_load_dwordx4 v13, s[8:11], s40 offen sc1 lds
    s_add_u32 m0, s39, 5136
    s_nop 0
    buffer_load_dwordx4 v14, s[8:11], s40 offen sc1 lds
    s_add_u32 s40, s40, s46
    s_add_u32 m0, s39, 6176
    s_nop 0
    buffer_load_dwordx4 v12, s[8:11], s40 offen sc1 lds
    s_add_u32 m0, s39, 7200
    s_nop 0
    buffer_load_dwordx4 v13, s[8:11], s40 offen sc1 lds
    s_add_u32 m0, s39, 8224
    s_nop 0
    buffer_load_dwordx4 v14, s[8:11], s40 offen sc1 lds
    s_cmp_lg_u32 s37, 3
    s_cbranch_scc1 L_pq_6
    buffer_load_dword v30, v31, s[4:7], 0 offen offset:640
L_pq_6:
    s_add_u32 s34, s34, 128
    s_add_u32 s35, s35, 128
    s_add_u32 s36, s36, s45
    s_add_u32 s38, s38, 53376
    s_cmp_eq_u32 s38, 160128
    s_cselect_b32 s38, 0, s38
    s_add_u32 s37, s37, 1
    s_cmp_lt_u32 s37, 9
    s_cbranch_scc1 L_f3_kernel_ldloop
    s_waitcnt vmcnt(26)
    s_barrier
    s_mov_b32 s14, 20733952
    s_mov_b32 s15, 0x00020000
    s_mov_b32 s18, 1152
    s_mov_b32 s19, 0x00020000
    s_lshl_b32 s40, s22, 8
    s_lshl_b32 s39, s21, 3
    s_add_u32 s40, s40, s39
    s_lshl_b32 s39, s25, 2
    s_add_u32 s40, s40, s39
    v_lshrrev_b32 v21, 4, v0
    v_add_u32 v21, s40, v21
    v_and_b32 v3, 15, v0
    v_lshlrev_b32 v22, 4, v3
    v_mul_u32_u24 v5, 1152, v21
    v_add_u32 v5, v5, v22
    buffer_load_dwordx4 v[32:35], v5, s[4:7], 0 offen offset:0
    buffer_load_dwordx4 v[56:59], v22, s[16:19], 0 offen offset:0
    buffer_load_dwordx4 v[36:39], v5, s[4:7], 0 offen offset:256
    buffer_load_dwordx4 v[60:63], v22, s[16:19], 0 offen offset:256
    buffer_load_dwordx4 v[40:43], v5, s[4:7], 0 offen offset:512
    buffer_load_dwordx4 v[64:67], v22, s[16:19], 0 offen offset:512
    buffer_load_dwordx4 v[44:47], v5, s[4:7], 0 offen offset:768
    buffer_load_dwordx4 v[68:71], v22, s[16:19], 0 offen offset:768
    buffer_load_dwordx4 v[48:51], v5, s[4:7], 0 offen offset:1024
    buffer_load_dwordx4 v[72:75], v22, s[16:19], 0 offen offset:1024
    v_lshlrev_b32 v21, 2, v21
    v_mov_b32 v6, 268435456
    v_cmp_eq_u32 vcc, 15, v3
    s_nop 1
    v_cndmask_b32 v23, v6, v21, vcc
    v_cmp_gt_u32 vcc, 16, v0
    v_lshlrev_b32 v26, 4, v0
    s_nop 0
    v_cndmask_b32 v27, v6, v26, vcc
    s_cmp_ge_u32 s2, 144
    s_cbranch_scc1 L_norp_7
    s_cmp_ge_u32 s2, 72
    s_cselect_b32 s8, s52, s50
    s_cselect_b32 s9, s53, s51
    s_cselect_b32 s33, 8, 0
    s_cselect_b32 s40, 72, 0
    s_mov_b32 s10, 663552
    s_sub_u32 s40, s2, s40
    s_lshl_b32 s40, s40, 2
    s_lshl_b32 s39, s25, 1
    s_add_u32 s40, s40, s39
    s_mul_i32 s26, s40, 1821
    s_lshr_b32 s26, s26, 16
    s_mul_i32 s39, s26, 36
    s_sub_u32 s27, s40, s39
    s_sub_u32 s28, s27, 4
    s_mul_i32 s31, s28, 20736
    s_add_u32 s32, s31, 23040
    s_mul_i32 s39, s27, 165888
    s_add_u32 s39, s39, 18432
    s_add_u32 s40, s39, 165888
    s_cmp_lt_u32 s27, 4
    s_cselect_b32 s31, s39, s31
    s_cselect_b32 s32, s40, s32
    s_mov_b32 s29, 9216
    s_mov_b32 s30, 4608
    s_cselect_b32 s29, 82944, s29
    s_cselect_b32 s30, 41472, s30
    s_add_u32 s33, s33, s26
    s_mul_i32 s33, s33, 82944
    s_mul_i32 s39, s27, 2304
    s_add_u32 s33, s33, s39
    s_add_u32 s33, s33, 19406848
    s_mul_i32 s26, s26, 144
    v_and_b32 v1, 16, v0
    v_and_b32 v2, 3, v0
    v_add_u32 v1, v1, v2
    v_and_b32 v2, 4, v0
    v_lshl_add_u32 v1, v2, 1, v1
    v_and_b32 v2, 8, v0
    v_lshrrev_b32 v2, 1, v2
    v_add_u32 v1, v1, v2
    v_lshlrev_b32 v1, 1, v1
    v_lshrrev_b32 v2, 5, v0
    v_mul_lo_u32 v2, v2, s29
    v_add3_u32 v24, v1, v2, s26
    v_and_b32 v1, 7, v0
    v_lshlrev_b32 v1, 1, v1
    v_bfe_u32 v2, v0, 3, 1
    v_mul_lo_u32 v2, v2, s29
    v_add3_u32 v1, v1, v2, s26
    v_add_u32 v1, 128, v1
    v_cmp_gt_u32 vcc, 16, v0
    s_nop 1
    v_cndmask_b32 v25, v6, v1, vcc
    s_add_u32 s39, s31, s30
    buffer_load_ushort v84, v24, s[8:11], s31 offen offset:0
    buffer_load_ushort v85, v24, s[8:11], s31 offen offset:1152
    buffer_load_ushort v86, v24, s[8:11], s31 offen offset:2304
    buffer_load_ushort v87, v24, s[8:11], s31 offen offset:3456
    buffer_load_ushort v88, v24, s[8:11], s39 offen offset:0
    buffer_load_ushort v89, v24, s[8:11], s39 offen offset:1152
    buffer_load_ushort v90, v24, s[8:11], s39 offen offset:2304
    buffer_load_ushort v91, v24, s[8:11], s39 offen offset:3456
    buffer_load_ushort v92, v24, s[8:11], s31 offen offset:64
    buffer_load_ushort v93, v24, s[8:11], s31 offen offset:1216
    buffer_load_ushort v94, v24, s[8:11], s31 offen offset:2368
    buffer_load_ushort v95, v24, s[8:11], s31 offen offset:3520
    buffer_load_ushort v96, v24, s[8:11], s39 offen offset:64
    buffer_load_ushort v97, v24, s[8:11], s39 offen offset:1216
    buffer_load_ushort v98, v24, s[8:11], s39 offen offset:2368
    buffer_load_ushort v99, v24, s[8:11], s39 offen offset:3520
    buffer_load_ushort v100, v25, s[8:11], s31 offen offset:0
    buffer_load_ushort v101, v25, s[8:11], s31 offen offset:1152
    buffer_load_ushort v102, v25, s[8:11], s31 offen offset:2304
    buffer_load_ushort v103, v25, s[8:11], s31 offen offset:3456
    buffer_load_ushort v104, v25, s[8:11], s39 offen offset:0
    buffer_load_ushort v105, v25, s[8:11], s39 offen offset:1152
    buffer_load_ushort v106, v25, s[8:11], s39 offen offset:2304
    buffer_load_ushort v107, v25, s[8:11], s39 offen offset:3456
    s_add_u32 s39, s32, s30
    buffer_load_ushort v108, v24, s[8:11], s32 offen offset:0
    buffer_load_ushort v109, v24, s[8:11], s32 offen offset:1152
    buffer_load_ushort v110, v24, s[8:11], s32 offen offset:2304
    buffer_load_ushort v111, v24, s[8:11], s32 offen offset:3456
    buffer_load_ushort v112, v24, s[8:11], s39 offen offset:0
    buffer_load_ushort v113, v24, s[8:11], s39 offen offset:1152
    buffer_load_ushort v114, v24, s[8:11], s39 offen offset:2304
    buffer_load_ushort v115, v24, s[8:11], s39 offen offset:3456
    buffer_load_ushort v116, v24, s[8:11], s32 offen offset:64
    buffer_load_ushort v117, v24, s[8:11], s32 offen offset:1216
    buffer_load_ushort v118, v24, s[8:11], s32 offen offset:2368
    buffer_load_ushort v119, v24, s[8:11], s32 offen offset:3520
    buffer_load_ushort v120, v24, s[8:11], s39 offen offset:64
    buffer_load_ushort v121, v24, s[8:11], s39 offen offset:1216
    buffer_load_ushort v122, v24, s[8:11], s39 offen offset:2368
    buffer_load_ushort v123, v24, s[8:11], s39 offen offset:3520
    buffer_load_ushort v124, v25, s[8:11], s32 offen offset:0
    buffer_load_ushort v125, v25, s[8:11], s32 offen offset:1152
    buffer_load_ushort v126, v25, s[8:11], s32 offen offset:2304
    buffer_load_ushort v127, v25, s[8:11], s32 offen offset:3456
    buffer_load_ushort v128, v25, s[8:11], s39 offen offset:0
    buffer_load_ushort v129, v25, s[8:11], s39 offen offset:1152
    buffer_load_ushort v130, v25, s[8:11], s39 offen offset:2304
    buffer_load_ushort v131, v25, s[8:11], s39 offen offset:3456
    s_waitcnt vmcnt(58)
    s_barrier
    s_branch L_norp2_8
L_norp_7:
    s_waitcnt vmcnt(10)
    s_barrier
L_norp2_8:
    s_waitcnt vmcnt(0)
    s_cmp_ge_u32 s2, 144
    s_cbranch_scc1 L_f3_kernel_gate
    v_lshl_or_b32 v84, v85, 16, v84
    v_lshl_or_b32 v85, v87, 16, v86
    v_lshl_or_b32 v86, v89, 16, v88
    v_lshl_or_b32 v87, v91, 16, v90
    buffer_store_dwordx4 v[84:87], v26, s[12:15], s33 offen offset:0 sc1
    v_lshl_or_b32 v92, v93, 16, v92
    v_lshl_or_b32 v93, v95, 16, v94
    v_lshl_or_b32 v94, v97, 16, v96
    v_lshl_or_b32 v95, v99, 16, v98
    buffer_store_dwordx4 v[92:95], v26, s[12:15], s33 offen offset:1024 sc1
    v_lshl_or_b32 v100, v101, 16, v100
    v_lshl_or_b32 v101, v103, 16, v102
    v_lshl_or_b32 v102, v105, 16, v104
    v_lshl_or_b32 v103, v107, 16, v106
    buffer_store_dwordx4 v[100:103], v27, s[12:15], s33 offen offset:2048 sc1
    s_add_u32 s33, s33, 2304
    v_lshl_or_b32 v108, v109, 16, v108
    v_lshl_or_b32 v109, v111, 16, v110
    v_lshl_or_b32 v110, v113, 16, v112
    v_lshl_or_b32 v111, v115, 16, v114
    buffer_store_dwordx4 v[108:111], v26, s[12:15], s33 offen offset:0 sc1
    v_lshl_or_b32 v116, v117, 16, v116
    v_lshl_or_b32 v117, v119, 16, v118
    v_lshl_or_b32 v118, v121, 16, v120
    v_lshl_or_b32 v119, v123, 16, v122
    buffer_store_dwordx4 v[116:119], v26, s[12:15], s33 offen offset:1024 sc1
    v_lshl_or_b32 v124, v125, 16, v124
    v_lshl_or_b32 v125, v127, 16, v126
    v_lshl_or_b32 v126, v129, 16, v128
    v_lshl_or_b32 v127, v131, 16, v130
    buffer_store_dwordx4 v[124:127], v27, s[12:15], s33 offen offset:2048 sc1
L_f3_kernel_gate:
    v_mov_b32 v80, 0
    v_mov_b32 v81, 0
    v_mov_b32 v82, 0
    v_mov_b32 v83, 0
    v_dot2_f32_bf16 v80, v32, v56, v80
    v_dot2_f32_bf16 v81, v33, v57, v81
    v_dot2_f32_bf16 v82, v34, v58, v82
    v_dot2_f32_bf16 v83, v35, v59, v83
    v_dot2_f32_bf16 v80, v36, v60, v80
    v_dot2_f32_bf16 v81, v37, v61, v81
    v_dot2_f32_bf16 v82, v38, v62, v82
    v_dot2_f32_bf16 v83, v39, v63, v83
    v_dot2_f32_bf16 v80, v40, v64, v80
    v_dot2_f32_bf16 v81, v41, v65, v81
    v_dot2_f32_bf16 v82, v42, v66, v82
    v_dot2_f32_bf16 v83, v43, v67, v83
    v_dot2_f32_bf16 v80, v44, v68, v80
    v_dot2_f32_bf16 v81, v45, v69, v81
    v_dot2_f32_bf16 v82, v46, v70, v82
    v_dot2_f32_bf16 v83, v47, v71, v83
    v_dot2_f32_bf16 v80, v48, v72, v80
    v_dot2_f32_bf16 v81, v49, v73, v81
    v_dot2_f32_bf16 v82, v50, v74, v82
    v_dot2_f32_bf16 v83, v51, v75, v83
    s_nop 0
    v_add_f32 v80, v80, v81
    s_nop 0
    v_add_f32 v82, v82, v83
    v_add_f32 v80, v80, v82
    s_nop 1
    v_add_f32_dpp v80, v80, v80 row_shr:1 row_mask:0xf bank_mask:0xf bound_ctrl:1
    s_nop 1
    v_add_f32_dpp v80, v80, v80 row_shr:2 row_mask:0xf bank_mask:0xf bound_ctrl:1
    s_nop 1
    v_add_f32_dpp v80, v80, v80 row_shr:4 row_mask:0xf bank_mask:0xf bound_ctrl:1
    s_nop 1
    v_add_f32_dpp v80, v80, v80 row_shr:8 row_mask:0xf bank_mask:0xf bound_ctrl:1
    v_mul_f32 v80, 0xbfb8aa3b, v80
    v_exp_f32 v80, v80
    s_nop 0
    v_add_f32 v80, 1.0, v80
    v_rcp_f32 v80, v80
    buffer_store_dword v80, v23, s[12:15], 0 offen offset:0 sc1
    v_lshlrev_b32 v1, 4, v0
    s_mul_i32 s26, s25, 9216
    v_add_u32 v2, s26, v1
    s_mul_i32 s43, s21, 155648
    s_add_u32 s43, s43, 2367488
    s_add_u32 s43, s43, s26
    s_mul_i32 s27, s22, 19456
    s_add_u32 s46, s43, s27
    v_mov_b32 v3, 160128
    s_lshl_b32 s28, s21, 7
    s_add_u32 s28, s28, 8192
    s_lshl_b32 s29, s22, 1
    s_add_u32 s29, s29, s25
    s_lshl_b32 s29, s29, 2
    v_mov_b32 v6, 268435456
    v_mov_b32 v7, s29
    v_cmp_eq_u32 vcc, 0, v0
    s_nop 1
    v_cndmask_b32 v4, v6, v7, vcc
    v_lshlrev_b32 v7, 2, v0
    v_cmp_gt_u32 vcc, 16, v0
    s_nop 1
    v_cndmask_b32 v5, v6, v7, vcc
    s_setprio 3
    s_barrier
    ds_read_b32 v3, v3
    ds_read_b128 v[32:35], v2 offset:0
    ds_read_b128 v[36:39], v2 offset:1024
    ds_read_b128 v[40:43], v2 offset:2048
    ds_read_b128 v[44:47], v2 offset:3072
    ds_read_b128 v[48:51], v2 offset:4096
    ds_read_b128 v[52:55], v2 offset:5120
    ds_read_b128 v[56:59], v2 offset:6144
    ds_read_b128 v[60:63], v2 offset:7168
    ds_read_b128 v[64:67], v2 offset:8192
    ds_read_b128 v[68:71], v2 offset:9216
    s_waitcnt lgkmcnt(9)
    buffer_store_dwordx4 v[32:35], v1, s[12:15], s46 offen sc1
    s_add_u32 s46, s46, 1024
    s_waitcnt lgkmcnt(8)
    buffer_store_dwordx4 v[36:39], v1, s[12:15], s46 offen sc1
    s_add_u32 s46, s46, 1024
    s_waitcnt lgkmcnt(7)
    buffer_store_dwordx4 v[40:43], v1, s[12:15], s46 offen sc1
    s_add_u32 s46, s46, 1024
    s_waitcnt lgkmcnt(6)
    buffer_store_dwordx4 v[44:47], v1, s[12:15], s46 offen sc1
    s_add_u32 s46, s46, 1024
    s_waitcnt lgkmcnt(5)
    buffer_store_dwordx4 v[48:51], v1, s[12:15], s46 offen sc1
    s_add_u32 s46, s46, 1024
    s_waitcnt lgkmcnt(4)
    buffer_store_dwordx4 v[52:55], v1, s[12:15], s46 offen sc1
    s_add_u32 s46, s46, 1024
    s_waitcnt lgkmcnt(3)
    buffer_store_dwordx4 v[56:59], v1, s[12:15], s46 offen sc1
    s_add_u32 s46, s46, 1024
    s_waitcnt lgkmcnt(2)
    buffer_store_dwordx4 v[60:63], v1, s[12:15], s46 offen sc1
    s_add_u32 s46, s46, 1024
    s_waitcnt lgkmcnt(1)
    buffer_store_dwordx4 v[64:67], v1, s[12:15], s46 offen sc1
    s_add_u32 s46, s46, 1024
    s_waitcnt lgkmcnt(0)
    buffer_store_dwordx4 v[68:71], v1, s[12:15], s46 offen sc1
    buffer_load_dword v7, v5, s[12:15], s28 offen sc1
    v_readfirstlane_b32 s44, v3
    s_add_u32 s38, s22, 1
    s_and_b32 s38, s38, 7
    s_lshl_b32 s38, s38, 1
    s_add_u32 s38, s38, s25
    s_lshl_b32 s39, s22, 1
    s_add_u32 s39, s39, s25
    s_lshl_b32 s39, 1, s39
    s_lshl_b32 s30, 0x5555, s25
    s_andn2_b32 s39, s30, s39
    s_mov_b32 s47, 0
    s_barrier
    s_waitcnt vmcnt(1)
    v_mov_b32 v6, s44
    buffer_store_dword v6, v4, s[12:15], s28 offen sc1
    s_waitcnt vmcnt(1)
    s_branch L_pchk_11
L_poll_9:
    buffer_load_dword v7, v5, s[12:15], s28 offen sc1
    s_add_u32 s47, s47, 1
    s_cmp_ge_u32 s47, 65536
    s_cbranch_scc1 L_pdone_10
    s_waitcnt vmcnt(0)
L_pchk_11:
    v_cmp_eq_u32 vcc, s44, v7
    s_bitcmp1_b32 vcc_lo, s38
    s_cbranch_scc0 L_poll_9
L_pdone_10:
    s_add_u32 s30, s22, 1
    s_and_b32 s30, s30, 7
    s_mul_i32 s30, s30, 19456
    s_add_u32 s45, s43, s30
    s_add_u32 m0, s26, 19456
    s_nop 0
    buffer_load_dwordx4 v1, s[12:15], s45 offen sc1 lds
    s_add_u32 m0, m0, 1024
    s_add_u32 s45, s45, 1024
    buffer_load_dwordx4 v1, s[12:15], s45 offen sc1 lds
    s_add_u32 m0, m0, 1024
    s_add_u32 s45, s45, 1024
    buffer_load_dwordx4 v1, s[12:15], s45 offen sc1 lds
    s_add_u32 m0, m0, 1024
    s_add_u32 s45, s45, 1024
    buffer_load_dwordx4 v1, s[12:15], s45 offen sc1 lds
    s_add_u32 m0, m0, 1024
    s_add_u32 s45, s45, 1024
    buffer_load_dwordx4 v1, s[12:15], s45 offen sc1 lds
    s_add_u32 m0, m0, 1024
    s_add_u32 s45, s45, 1024
    buffer_load_dwordx4 v1, s[12:15], s45 offen sc1 lds
    s_add_u32 m0, m0, 1024
    s_add_u32 s45, s45, 1024
    buffer_load_dwordx4 v1, s[12:15], s45 offen sc1 lds
    s_add_u32 m0, m0, 1024
    s_add_u32 s45, s45, 1024
    buffer_load_dwordx4 v1, s[12:15], s45 offen sc1 lds
    s_add_u32 m0, m0, 1024
    s_add_u32 s45, s45, 1024
    buffer_load_dwordx4 v1, s[12:15], s45 offen sc1 lds
    s_add_u32 m0, m0, 1024
    s_add_u32 s45, s45, 1024
    buffer_load_dwordx4 v1, s[12:15], s45 offen sc1 lds
    buffer_load_dword v7, v5, s[12:15], s28 offen sc1
    s_lshl_b32 s34, s21, 3
    s_add_u32 s34, s34, s22
    s_lshl_b32 s34, s34, 2
    s_add_u32 s34, s34, 32768
    s_cmp_eq_u32 s25, 0
    s_cselect_b64 s[36:37], 1, 0
    v_mov_b32 v8, 268435456
    v_cndmask_b32 v8, v8, 0, s[36:37]
    v_mov_b32 v6, s44
    v_lshrrev_b32 v9, 4, v0
    v_lshlrev_b32 v9, 6, v9
    v_bfe_u32 v10, v0, 3, 2
    v_lshlrev_b32 v10, 6, v10
    s_mov_b32 s16, s54
    s_mov_b32 s17, s55
    s_mov_b32 s18, 256
    s_mov_b32 s19, 0x00020000
    s_waitcnt vmcnt(0)
    v_cmp_eq_u32 vcc, s44, v7
    s_and_b32 s30, vcc_lo, s39
    s_cmp_eq_u32 s30, s39
    s_cselect_b32 s38, 1, 0
    s_barrier
    buffer_store_dword v6, v8, s[12:15], s34 offen sc1
    s_cmp_eq_u32 s38, 1
    s_cbranch_scc1 L_nall2_13
L_poll2_14:
    buffer_load_dword v7, v5, s[12:15], s28 offen sc1
    s_add_u32 s47, s47, 1
    s_cmp_ge_u32 s47, 65536
    s_cbranch_scc1 L_pdone2_15
    s_waitcnt vmcnt(0)
    v_cmp_eq_u32 vcc, s44, v7
    s_and_b32 s30, vcc_lo, s39
    s_cmp_eq_u32 s30, s39
    s_cbranch_scc0 L_poll2_14
L_pdone2_15:
L_nall2_13:
    s_add_u32 s30, s22, 2
    s_and_b32 s30, s30, 7
    s_mul_i32 s30, s30, 19456
    s_add_u32 s45, s43, s30
    s_add_u32 m0, s26, 38912
    s_nop 0
    buffer_load_dwordx4 v1, s[12:15], s45 offen sc1 lds
    s_add_u32 m0, m0, 1024
    s_add_u32 s45, s45, 1024
    buffer_load_dwordx4 v1, s[12:15], s45 offen sc1 lds
    s_add_u32 m0, m0, 1024
    s_add_u32 s45, s45, 1024
    buffer_load_dwordx4 v1, s[12:15], s45 offen sc1 lds
    s_add_u32 m0, m0, 1024
    s_add_u32 s45, s45, 1024
    buffer_load_dwordx4 v1, s[12:15], s45 offen sc1 lds
    s_add_u32 m0, m0, 1024
    s_add_u32 s45, s45, 1024
    buffer_load_dwordx4 v1, s[12:15], s45 offen sc1 lds
    s_add_u32 m0, m0, 1024
    s_add_u32 s45, s45, 1024
    buffer_load_dwordx4 v1, s[12:15], s45 offen sc1 lds
    s_add_u32 m0, m0, 1024
    s_add_u32 s45, s45, 1024
    buffer_load_dwordx4 v1, s[12:15], s45 offen sc1 lds
    s_add_u32 m0, m0, 1024
    s_add_u32 s45, s45, 1024
    buffer_load_dwordx4 v1, s[12:15], s45 offen sc1 lds
    s_add_u32 m0, m0, 1024
    s_add_u32 s45, s45, 1024
    buffer_load_dwordx4 v1, s[12:15], s45 offen sc1 lds
    s_add_u32 m0, m0, 1024
    s_add_u32 s45, s45, 1024
    buffer_load_dwordx4 v1, s[12:15], s45 offen sc1 lds
    s_add_u32 s30, s22, 3
    s_and_b32 s30, s30, 7
    s_mul_i32 s30, s30, 19456
    s_add_u32 s45, s43, s30
    s_add_u32 m0, s26, 58368
    s_nop 0
    buffer_load_dwordx4 v1, s[12:15], s45 offen sc1 lds
    s_add_u32 m0, m0, 1024
    s_add_u32 s45, s45, 1024
    buffer_load_dwordx4 v1, s[12:15], s45 offen sc1 lds
    s_add_u32 m0, m0, 1024
    s_add_u32 s45, s45, 1024
    buffer_load_dwordx4 v1, s[12:15], s45 offen sc1 lds
    s_add_u32 m0, m0, 1024
    s_add_u32 s45, s45, 1024
    buffer_load_dwordx4 v1, s[12:15], s45 offen sc1 lds
    s_add_u32 m0, m0, 1024
    s_add_u32 s45, s45, 1024
    buffer_load_dwordx4 v1, s[12:15], s45 offen sc1 lds
    s_add_u32 m0, m0, 1024
    s_add_u32 s45, s45, 1024
    buffer_load_dwordx4 v1, s[12:15], s45 offen sc1 lds
    s_add_u32 m0, m0, 1024
    s_add_u32 s45, s45, 1024
    buffer_load_dwordx4 v1, s[12:15], s45 offen sc1 lds
    s_add_u32 m0, m0, 1024
    s_add_u32 s45, s45, 1024
    buffer_load_dwordx4 v1, s[12:15], s45 offen sc1 lds
    s_add_u32 m0, m0, 1024
    s_add_u32 s45, s45, 1024
    buffer_load_dwordx4 v1, s[12:15], s45 offen sc1 lds
    s_add_u32 m0, m0, 1024
    s_add_u32 s45, s45, 1024
    buffer_load_dwordx4 v1, s[12:15], s45 offen sc1 lds
    s_add_u32 s30, s22, 4
    s_and_b32 s30, s30, 7
    s_mul_i32 s30, s30, 19456
    s_add_u32 s45, s43, s30
    s_add_u32 m0, s26, 77824
    s_nop 0
    buffer_load_dwordx4 v1, s[12:15], s45 offen sc1 lds
    s_add_u32 m0, m0, 1024
    s_add_u32 s45, s45, 1024
    buffer_load_dwordx4 v1, s[12:15], s45 offen sc1 lds
    s_add_u32 m0, m0, 1024
    s_add_u32 s45, s45, 1024
    buffer_load_dwordx4 v1, s[12:15], s45 offen sc1 lds
    s_add_u32 m0, m0, 1024
    s_add_u32 s45, s45, 1024
    buffer_load_dwordx4 v1, s[12:15], s45 offen sc1 lds
    s_add_u32 m0, m0, 1024
    s_add_u32 s45, s45, 1024
    buffer_load_dwordx4 v1, s[12:15], s45 offen sc1 lds
    s_add_u32 m0, m0, 1024
    s_add_u32 s45, s45, 1024
    buffer_load_dwordx4 v1, s[12:15], s45 offen sc1 lds
    s_add_u32 m0, m0, 1024
    s_add_u32 s45, s45, 1024
    buffer_load_dwordx4 v1, s[12:15], s45 offen sc1 lds
    s_add_u32 m0, m0, 1024
    s_add_u32 s45, s45, 1024
    buffer_load_dwordx4 v1, s[12:15], s45 offen sc1 lds
    s_add_u32 m0, m0, 1024
    s_add_u32 s45, s45, 1024
    buffer_load_dwordx4 v1, s[12:15], s45 offen sc1 lds
    s_add_u32 m0, m0, 1024
    s_add_u32 s45, s45, 1024
    buffer_load_dwordx4 v1, s[12:15], s45 offen sc1 lds
    s_add_u32 s30, s22, 5
    s_and_b32 s30, s30, 7
    s_mul_i32 s30, s30, 19456
    s_add_u32 s45, s43, s30
    s_add_u32 m0, s26, 97280
    s_nop 0
    buffer_load_dwordx4 v1, s[12:15], s45 offen sc1 lds
    s_add_u32 m0, m0, 1024
    s_add_u32 s45, s45, 1024
    buffer_load_dwordx4 v1, s[12:15], s45 offen sc1 lds
    s_add_u32 m0, m0, 1024
    s_add_u32 s45, s45, 1024
    buffer_load_dwordx4 v1, s[12:15], s45 offen sc1 lds
    s_add_u32 m0, m0, 1024
    s_add_u32 s45, s45, 1024
    buffer_load_dwordx4 v1, s[12:15], s45 offen sc1 lds
    s_add_u32 m0, m0, 1024
    s_add_u32 s45, s45, 1024
    buffer_load_dwordx4 v1, s[12:15], s45 offen sc1 lds
    s_add_u32 m0, m0, 1024
    s_add_u32 s45, s45, 1024
    buffer_load_dwordx4 v1, s[12:15], s45 offen sc1 lds
    s_add_u32 m0, m0, 1024
    s_add_u32 s45, s45, 1024
    buffer_load_dwordx4 v1, s[12:15], s45 offen sc1 lds
    s_add_u32 m0, m0, 1024
    s_add_u32 s45, s45, 1024
    buffer_load_dwordx4 v1, s[12:15], s45 offen sc1 lds
    s_add_u32 m0, m0, 1024
    s_add_u32 s45, s45, 1024
    buffer_load_dwordx4 v1, s[12:15], s45 offen sc1 lds
    s_add_u32 m0, m0, 1024
    s_add_u32 s45, s45, 1024
    buffer_load_dwordx4 v1, s[12:15], s45 offen sc1 lds
    s_waitcnt vmcnt(20)
    s_barrier
    s_add_u32 s30, s22, 6
    s_and_b32 s30, s30, 7
    s_mul_i32 s30, s30, 19456
    s_add_u32 s45, s43, s30
    s_add_u32 m0, s26, 116736
    s_nop 0
    buffer_load_dwordx4 v1, s[12:15], s45 offen sc1 lds
    s_add_u32 m0, m0, 1024
    s_add_u32 s45, s45, 1024
    buffer_load_dwordx4 v1, s[12:15], s45 offen sc1 lds
    s_add_u32 m0, m0, 1024
    s_add_u32 s45, s45, 1024
    buffer_load_dwordx4 v1, s[12:15], s45 offen sc1 lds
    s_add_u32 m0, m0, 1024
    s_add_u32 s45, s45, 1024
    buffer_load_dwordx4 v1, s[12:15], s45 offen sc1 lds
    s_add_u32 m0, m0, 1024
    s_add_u32 s45, s45, 1024
    buffer_load_dwordx4 v1, s[12:15], s45 offen sc1 lds
    s_add_u32 m0, m0, 1024
    s_add_u32 s45, s45, 1024
    buffer_load_dwordx4 v1, s[12:15], s45 offen sc1 lds
    s_add_u32 m0, m0, 1024
    s_add_u32 s45, s45, 1024
    buffer_load_dwordx4 v1, s[12:15], s45 offen sc1 lds
    s_add_u32 m0, m0, 1024
    s_add_u32 s45, s45, 1024
    buffer_load_dwordx4 v1, s[12:15], s45 offen sc1 lds
    s_add_u32 m0, m0, 1024
    s_add_u32 s45, s45, 1024
    buffer_load_dwordx4 v1, s[12:15], s45 offen sc1 lds
    s_add_u32 m0, m0, 1024
    s_add_u32 s45, s45, 1024
    buffer_load_dwordx4 v1, s[12:15], s45 offen sc1 lds
    s_add_u32 s30, s22, 7
    s_and_b32 s30, s30, 7
    s_mul_i32 s30, s30, 19456
    s_add_u32 s45, s43, s30
    s_add_u32 m0, s26, 136192
    s_nop 0
    buffer_load_dwordx4 v1, s[12:15], s45 offen sc1 lds
    s_add_u32 m0, m0, 1024
    s_add_u32 s45, s45, 1024
    buffer_load_dwordx4 v1, s[12:15], s45 offen sc1 lds
    s_add_u32 m0, m0, 1024
    s_add_u32 s45, s45, 1024
    buffer_load_dwordx4 v1, s[12:15], s45 offen sc1 lds
    s_add_u32 m0, m0, 1024
    s_add_u32 s45, s45, 1024
    buffer_load_dwordx4 v1, s[12:15], s45 offen sc1 lds
    s_add_u32 m0, m0, 1024
    s_add_u32 s45, s45, 1024
    buffer_load_dwordx4 v1, s[12:15], s45 offen sc1 lds
    s_add_u32 m0, m0, 1024
    s_add_u32 s45, s45, 1024
    buffer_load_dwordx4 v1, s[12:15], s45 offen sc1 lds
    s_add_u32 m0, m0, 1024
    s_add_u32 s45, s45, 1024
    buffer_load_dwordx4 v1, s[12:15], s45 offen sc1 lds
    s_add_u32 m0, m0, 1024
    s_add_u32 s45, s45, 1024
    buffer_load_dwordx4 v1, s[12:15], s45 offen sc1 lds
    s_add_u32 m0, m0, 1024
    s_add_u32 s45, s45, 1024
    buffer_load_dwordx4 v1, s[12:15], s45 offen sc1 lds
    s_add_u32 m0, m0, 1024
    s_add_u32 s45, s45, 1024
    buffer_load_dwordx4 v1, s[12:15], s45 offen sc1 lds
    s_mov_b32 s47, 0
    s_mov_b32 s34, 32768
L_apl_16:
    buffer_load_dword v11, v9, s[16:19], 0 offen sc1
    buffer_load_dwordx4 v[12:15], v1, s[12:15], s34 offen sc1
    s_add_u32 s47, s47, 1
    s_cmp_ge_u32 s47, 65536
    s_cbranch_scc1 L_apd_17
    s_waitcnt vmcnt(0)
    v_cmp_ne_u32 s[36:37], 0, v11
    v_cmp_eq_u32 vcc, v12, v11
    s_and_b64 s[36:37], s[36:37], vcc
    v_cmp_eq_u32 vcc, v13, v11
    s_and_b64 s[36:37], s[36:37], vcc
    v_cmp_eq_u32 vcc, v14, v11
    s_and_b64 s[36:37], s[36:37], vcc
    v_cmp_eq_u32 vcc, v15, v11
    s_and_b64 s[36:37], s[36:37], vcc
    s_cmp_eq_u64 s[36:37], -1
    s_cbranch_scc0 L_apl_16
L_apd_17:
    s_waitcnt vmcnt(0)
    buffer_load_dword v3, v10, s[16:19], 0 offen sc1
    s_waitcnt vmcnt(0)
    s_setprio 0
    s_lshr_b32 s40, s21, 3
    s_lshl_b32 s40, s40, 1
    s_add_u32 s40, s40, s25
    s_lshl_b32 s30, s22, 3
    s_add_u32 s40, s40, s30
    s_mul_i32 s40, s40, 36864
    s_add_u32 s38, s40, 14688256
    s_and_b32 s30, s21, 7
    s_mul_i32 s30, s30, 82944
    s_add_u32 s39, s30, 19406848
    v_lshrrev_b32 v6, 5, v0
    v_lshlrev_b32 v6, 7, v6
    v_and_b32 v7, 7, v0
    v_lshl_add_u32 v4, v7, 4, v6
    v_and_b32 v6, 24, v0
    v_mov_b32 v7, 268435456
    v_cmp_ne_u32 vcc, 0, v6
    s_nop 1
    v_cndmask_b32 v4, v4, v7, vcc
    v_lshrrev_b32 v6, 5, v0
    v_lshlrev_b32 v6, 9, v6
    v_and_b32 v7, 31, v0
    v_lshl_add_u32 v160, v7, 2, v6
    buffer_load_dword v64, v160, s[12:15], s38 offen offset:0 sc1
    buffer_load_dword v65, v160, s[12:15], s38 offen offset:128 sc1
    buffer_load_dword v66, v160, s[12:15], s38 offen offset:256 sc1
    buffer_load_dword v67, v160, s[12:15], s38 offen offset:384 sc1
    buffer_load_dwordx4 v[68:71], v1, s[12:15], s39 offen
    buffer_load_dwordx4 v[72:75], v1, s[12:15], s39 offen offset:1024
    buffer_load_dwordx4 v[76:79], v4, s[12:15], s39 offen offset:2048
    s_add_u32 s39, s39, 2304
    buffer_load_dword v80, v160, s[12:15], s38 offen offset:1024 sc1
    buffer_load_dword v81, v160, s[12:15], s38 offen offset:1152 sc1
    buffer_load_dword v82, v160, s[12:15], s38 offen offset:1280 sc1
    buffer_load_dword v83, v160, s[12:15], s38 offen offset:1408 sc1
    buffer_load_dwordx4 v[84:87], v1, s[12:15], s39 offen
    buffer_load_dwordx4 v[88:91], v1, s[12:15], s39 offen offset:1024
    buffer_load_dwordx4 v[92:95], v4, s[12:15], s39 offen offset:2048
    s_add_u32 s39, s39, 2304
    buffer_load_dword v96, v160, s[12:15], s38 offen offset:2048 sc1
    buffer_load_dword v97, v160, s[12:15], s38 offen offset:2176 sc1
    buffer_load_dword v98, v160, s[12:15], s38 offen offset:2304 sc1
    buffer_load_dword v99, v160, s[12:15], s38 offen offset:2432 sc1
    buffer_load_dwordx4 v[100:103], v1, s[12:15], s39 offen
    buffer_load_dwordx4 v[104:107], v1, s[12:15], s39 offen offset:1024
    buffer_load_dwordx4 v[108:111], v4, s[12:15], s39 offen offset:2048
    s_add_u32 s39, s39, 2304
    buffer_load_dword v112, v160, s[12:15], s38 offen offset:3072 sc1
    buffer_load_dword v113, v160, s[12:15], s38 offen offset:3200 sc1
    buffer_load_dword v114, v160, s[12:15], s38 offen offset:3328 sc1
    buffer_load_dword v115, v160, s[12:15], s38 offen offset:3456 sc1
    buffer_load_dwordx4 v[116:119], v1, s[12:15], s39 offen
    buffer_load_dwordx4 v[120:123], v1, s[12:15], s39 offen offset:1024
    buffer_load_dwordx4 v[124:127], v4, s[12:15], s39 offen offset:2048
    s_add_u32 s39, s39, 2304
    s_add_u32 s38, s38, 4096
    buffer_load_dwordx4 v[128:131], v1, s[12:15], s38 offen offset:0 sc1
    buffer_load_dwordx4 v[132:135], v1, s[12:15], s39 offen
    buffer_load_dwordx4 v[136:139], v1, s[12:15], s39 offen offset:1024
    buffer_load_dwordx4 v[140:143], v4, s[12:15], s39 offen offset:2048
    s_add_u32 s39, s39, 2304
    buffer_load_dwordx4 v[144:147], v1, s[12:15], s38 offen offset:1024 sc1
    buffer_load_dwordx4 v[148:151], v1, s[12:15], s39 offen
    buffer_load_dwordx4 v[152:155], v1, s[12:15], s39 offen offset:1024
    buffer_load_dwordx4 v[156:159], v4, s[12:15], s39 offen offset:2048
    s_add_u32 s39, s39, 2304
    s_waitcnt vmcnt(29)
    v_mfma_f32_32x32x16_bf16 v[16:31], v[68:71], v[64:67], 0
    v_mfma_f32_32x32x16_bf16 v[32:47], v[72:75], v[64:67], 0
    v_mfma_f32_32x32x16_bf16 v[48:63], v[76:79], v[64:67], 0
    buffer_load_dwordx4 v[64:67], v1, s[12:15], s38 offen offset:2048 sc1
    buffer_load_dwordx4 v[68:71], v1, s[12:15], s39 offen
    buffer_load_dwordx4 v[72:75], v1, s[12:15], s39 offen offset:1024
    buffer_load_dwordx4 v[76:79], v4, s[12:15], s39 offen offset:2048
    s_add_u32 s39, s39, 2304
    s_waitcnt vmcnt(26)
    v_mfma_f32_32x32x16_bf16 v[16:31], v[84:87], v[80:83], v[16:31]
    v_mfma_f32_32x32x16_bf16 v[32:47], v[88:91], v[80:83], v[32:47]
    v_mfma_f32_32x32x16_bf16 v[48:63], v[92:95], v[80:83], v[48:63]
    buffer_load_dwordx4 v[80:83], v1, s[12:15], s38 offen offset:3072 sc1
    buffer_load_dwordx4 v[84:87], v1, s[12:15], s39 offen
    buffer_load_dwordx4 v[88:91], v1, s[12:15], s39 offen offset:1024
    buffer_load_dwordx4 v[92:95], v4, s[12:15], s39 offen offset:2048
    s_add_u32 s39, s39, 2304
    s_add_u32 s38, s38, 4096
    s_waitcnt vmcnt(23)
    v_mfma_f32_32x32x16_bf16 v[16:31], v[100:103], v[96:99], v[16:31]
    v_mfma_f32_32x32x16_bf16 v[32:47], v[104:107], v[96:99], v[32:47]
    v_mfma_f32_32x32x16_bf16 v[48:63], v[108:111], v[96:99], v[48:63]
    buffer_load_dwordx4 v[96:99], v1, s[12:15], s38 offen offset:0 sc1
    buffer_load_dwordx4 v[100:103], v1, s[12:15], s39 offen
    buffer_load_dwordx4 v[104:107], v1, s[12:15], s39 offen offset:1024
    buffer_load_dwordx4 v[108:111], v4, s[12:15], s39 offen offset:2048
    s_add_u32 s39, s39, 2304
    s_waitcnt vmcnt(20)
    v_mfma_f32_32x32x16_bf16 v[16:31], v[116:119], v[112:115], v[16:31]
    v_mfma_f32_32x32x16_bf16 v[32:47], v[120:123], v[112:115], v[32:47]
    v_mfma_f32_32x32x16_bf16 v[48:63], v[124:127], v[112:115], v[48:63]
    buffer_load_dwordx4 v[112:115], v1, s[12:15], s38 offen offset:1024 sc1
    buffer_load_dwordx4 v[116:119], v1, s[12:15], s39 offen
    buffer_load_dwordx4 v[120:123], v1, s[12:15], s39 offen offset:1024
    buffer_load_dwordx4 v[124:127], v4, s[12:15], s39 offen offset:2048
    s_add_u32 s39, s39, 2304
    s_barrier
    s_waitcnt vmcnt(20)
    v_mfma_f32_32x32x16_bf16 v[16:31], v[132:135], v[128:131], v[16:31]
    v_mfma_f32_32x32x16_bf16 v[32:47], v[136:139], v[128:131], v[32:47]
    v_mfma_f32_32x32x16_bf16 v[48:63], v[140:143], v[128:131], v[48:63]
    buffer_load_dwordx4 v[128:131], v1, s[12:15], s38 offen offset:2048 sc1
    buffer_load_dwordx4 v[132:135], v1, s[12:15], s39 offen
    buffer_load_dwordx4 v[136:139], v1, s[12:15], s39 offen offset:1024
    buffer_load_dwordx4 v[140:143], v4, s[12:15], s39 offen offset:2048
    s_add_u32 s39, s39, 2304
    s_waitcnt vmcnt(20)
    v_mfma_f32_32x32x16_bf16 v[16:31], v[148:151], v[144:147], v[16:31]
    v_mfma_f32_32x32x16_bf16 v[32:47], v[152:155], v[144:147], v[32:47]
    v_mfma_f32_32x32x16_bf16 v[48:63], v[156:159], v[144:147], v[48:63]
    buffer_load_dwordx4 v[144:147], v1, s[12:15], s38 offen offset:3072 sc1
    buffer_load_dwordx4 v[148:151], v1, s[12:15], s39 offen
    buffer_load_dwordx4 v[152:155], v1, s[12:15], s39 offen offset:1024
    buffer_load_dwordx4 v[156:159], v4, s[12:15], s39 offen offset:2048
    s_add_u32 s39, s39, 2304
    s_add_u32 s38, s38, 4096
    s_waitcnt vmcnt(20)
    v_mfma_f32_32x32x16_bf16 v[16:31], v[68:71], v[64:67], v[16:31]
    v_mfma_f32_32x32x16_bf16 v[32:47], v[72:75], v[64:67], v[32:47]
    v_mfma_f32_32x32x16_bf16 v[48:63], v[76:79], v[64:67], v[48:63]
    buffer_load_dwordx4 v[64:67], v1, s[12:15], s38 offen offset:0 sc1
    buffer_load_dwordx4 v[68:71], v1, s[12:15], s39 offen
    buffer_load_dwordx4 v[72:75], v1, s[12:15], s39 offen offset:1024
    buffer_load_dwordx4 v[76:79], v4, s[12:15], s39 offen offset:2048
    s_add_u32 s39, s39, 2304
    s_waitcnt vmcnt(20)
    v_mfma_f32_32x32x16_bf16 v[16:31], v[84:87], v[80:83], v[16:31]
    v_mfma_f32_32x32x16_bf16 v[32:47], v[88:91], v[80:83], v[32:47]
    v_mfma_f32_32x32x16_bf16 v[48:63], v[92:95], v[80:83], v[48:63]
    buffer_load_dwordx4 v[80:83], v1, s[12:15], s38 offen offset:1024 sc1
    buffer_load_dwordx4 v[84:87], v1, s[12:15], s39 offen
    buffer_load_dwordx4 v[88:91], v1, s[12:15], s39 offen offset:1024
    buffer_load_dwordx4 v[92:95], v4, s[12:15], s39 offen offset:2048
    s_add_u32 s39, s39, 2304
    s_waitcnt vmcnt(20)
    v_mfma_f32_32x32x16_bf16 v[16:31], v[100:103], v[96:99], v[16:31]
    v_mfma_f32_32x32x16_bf16 v[32:47], v[104:107], v[96:99], v[32:47]
    v_mfma_f32_32x32x16_bf16 v[48:63], v[108:111], v[96:99], v[48:63]
    buffer_load_dwordx4 v[96:99], v1, s[12:15], s38 offen offset:2048 sc1
    buffer_load_dwordx4 v[100:103], v1, s[12:15], s39 offen
    buffer_load_dwordx4 v[104:107], v1, s[12:15], s39 offen offset:1024
    buffer_load_dwordx4 v[108:111], v4, s[12:15], s39 offen offset:2048
    s_add_u32 s39, s39, 2304
    s_waitcnt vmcnt(20)
    v_mfma_f32_32x32x16_bf16 v[16:31], v[116:119], v[112:115], v[16:31]
    v_mfma_f32_32x32x16_bf16 v[32:47], v[120:123], v[112:115], v[32:47]
    v_mfma_f32_32x32x16_bf16 v[48:63], v[124:127], v[112:115], v[48:63]
    buffer_load_dwordx4 v[112:115], v1, s[12:15], s38 offen offset:3072 sc1
    buffer_load_dwordx4 v[116:119], v1, s[12:15], s39 offen
    buffer_load_dwordx4 v[120:123], v1, s[12:15], s39 offen offset:1024
    buffer_load_dwordx4 v[124:127], v4, s[12:15], s39 offen offset:2048
    s_add_u32 s39, s39, 2304
    s_add_u32 s38, s38, 4096
    s_waitcnt vmcnt(20)
    v_mfma_f32_32x32x16_bf16 v[16:31], v[132:135], v[128:131], v[16:31]
    v_mfma_f32_32x32x16_bf16 v[32:47], v[136:139], v[128:131], v[32:47]
    v_mfma_f32_32x32x16_bf16 v[48:63], v[140:143], v[128:131], v[48:63]
    buffer_load_dwordx4 v[128:131], v1, s[12:15], s38 offen offset:0 sc1
    buffer_load_dwordx4 v[132:135], v1, s[12:15], s39 offen
    buffer_load_dwordx4 v[136:139], v1, s[12:15], s39 offen offset:1024
    buffer_load_dwordx4 v[140:143], v4, s[12:15], s39 offen offset:2048
    s_add_u32 s39, s39, 2304
    s_waitcnt vmcnt(20)
    v_mfma_f32_32x32x16_bf16 v[16:31], v[148:151], v[144:147], v[16:31]
    v_mfma_f32_32x32x16_bf16 v[32:47], v[152:155], v[144:147], v[32:47]
    v_mfma_f32_32x32x16_bf16 v[48:63], v[156:159], v[144:147], v[48:63]
    buffer_load_dwordx4 v[144:147], v1, s[12:15], s38 offen offset:1024 sc1
    buffer_load_dwordx4 v[148:151], v1, s[12:15], s39 offen
    buffer_load_dwordx4 v[152:155], v1, s[12:15], s39 offen offset:1024
    buffer_load_dwordx4 v[156:159], v4, s[12:15], s39 offen offset:2048
    s_add_u32 s39, s39, 2304
    s_waitcnt vmcnt(20)
    v_mfma_f32_32x32x16_bf16 v[16:31], v[68:71], v[64:67], v[16:31]
    v_mfma_f32_32x32x16_bf16 v[32:47], v[72:75], v[64:67], v[32:47]
    v_mfma_f32_32x32x16_bf16 v[48:63], v[76:79], v[64:67], v[48:63]
    s_waitcnt vmcnt(16)
    v_mfma_f32_32x32x16_bf16 v[16:31], v[84:87], v[80:83], v[16:31]
    v_mfma_f32_32x32x16_bf16 v[32:47], v[88:91], v[80:83], v[32:47]
    v_mfma_f32_32x32x16_bf16 v[48:63], v[92:95], v[80:83], v[48:63]
    s_waitcnt vmcnt(12)
    v_mfma_f32_32x32x16_bf16 v[16:31], v[100:103], v[96:99], v[16:31]
    v_mfma_f32_32x32x16_bf16 v[32:47], v[104:107], v[96:99], v[32:47]
    v_mfma_f32_32x32x16_bf16 v[48:63], v[108:111], v[96:99], v[48:63]
    s_waitcnt vmcnt(8)
    v_mfma_f32_32x32x16_bf16 v[16:31], v[116:119], v[112:115], v[16:31]
    v_mfma_f32_32x32x16_bf16 v[32:47], v[120:123], v[112:115], v[32:47]
    v_mfma_f32_32x32x16_bf16 v[48:63], v[124:127], v[112:115], v[48:63]
    s_waitcnt vmcnt(4)
    v_mfma_f32_32x32x16_bf16 v[16:31], v[132:135], v[128:131], v[16:31]
    v_mfma_f32_32x32x16_bf16 v[32:47], v[136:139], v[128:131], v[32:47]
    v_mfma_f32_32x32x16_bf16 v[48:63], v[140:143], v[128:131], v[48:63]
    s_waitcnt vmcnt(0)
    v_mfma_f32_32x32x16_bf16 v[16:31], v[148:151], v[144:147], v[16:31]
    v_mfma_f32_32x32x16_bf16 v[32:47], v[152:155], v[144:147], v[32:47]
    v_mfma_f32_32x32x16_bf16 v[48:63], v[156:159], v[144:147], v[48:63]
    s_setprio 1
    s_lshl_b32 s34, s22, 3
    s_lshr_b32 s30, s21, 3
    s_lshl_b32 s30, s30, 1
    s_add_u32 s30, s30, s25
    s_add_u32 s34, s34, s30
    s_lshl_b32 s34, s34, 3
    s_and_b32 s30, s21, 7
    s_add_u32 s34, s34, s30
    s_lshl_b32 s34, s34, 7
    s_add_u32 s34, s34, 36864
    v_and_b32 v6, 31, v0
    v_lshlrev_b32 v5, 2, v6
    s_add_u32 s38, s40, 17047552
    s_mul_i32 s30, s25, 9216
    s_add_u32 s30, s30, 107520
    v_add_u32 v2, s30, v1
    v_and_b32 v6, 7, v0
    v_lshlrev_b32 v6, 2, v6
    v_add_u32 v6, 155648, v6
    s_barrier
    s_and_b32 s30, s21, 7
    s_add_u32 s30, s30, 8
    s_mul_i32 s30, s30, 82944
    s_mul_i32 s31, s25, 40960
    s_add_u32 s41, s30, s31
    s_add_u32 s41, s41, 19406848
    s_mov_b32 m0, s31
    s_nop 0
    buffer_load_dwordx4 v1, s[12:15], s41 offen offset:0 sc1 lds
    buffer_load_dwordx4 v1, s[12:15], s41 offen offset:1024 sc1 lds
    buffer_load_dwordx4 v1, s[12:15], s41 offen offset:2048 sc1 lds
    buffer_load_dwordx4 v1, s[12:15], s41 offen offset:3072 sc1 lds
    s_add_u32 m0, m0, 4096
    s_add_u32 s41, s41, 4096
    buffer_load_dwordx4 v1, s[12:15], s41 offen offset:0 sc1 lds
    buffer_load_dwordx4 v1, s[12:15], s41 offen offset:1024 sc1 lds
    buffer_load_dwordx4 v1, s[12:15], s41 offen offset:2048 sc1 lds
    buffer_load_dwordx4 v1, s[12:15], s41 offen offset:3072 sc1 lds
    s_add_u32 m0, m0, 4096
    s_add_u32 s41, s41, 4096
    buffer_load_dwordx4 v1, s[12:15], s41 offen offset:0 sc1 lds
    buffer_load_dwordx4 v1, s[12:15], s41 offen offset:1024 sc1 lds
    buffer_load_dwordx4 v1, s[12:15], s41 offen offset:2048 sc1 lds
    buffer_load_dwordx4 v1, s[12:15], s41 offen offset:3072 sc1 lds
    s_add_u32 m0, m0, 4096
    s_add_u32 s41, s41, 4096
    buffer_load_dwordx4 v1, s[12:15], s41 offen offset:0 sc1 lds
    buffer_load_dwordx4 v1, s[12:15], s41 offen offset:1024 sc1 lds
    buffer_load_dwordx4 v1, s[12:15], s41 offen offset:2048 sc1 lds
    buffer_load_dwordx4 v1, s[12:15], s41 offen offset:3072 sc1 lds
    s_add_u32 m0, m0, 4096
    s_add_u32 s41, s41, 4096
    buffer_load_dwordx4 v1, s[12:15], s41 offen offset:0 sc1 lds
    buffer_load_dwordx4 v1, s[12:15], s41 offen offset:1024 sc1 lds
    buffer_load_dwordx4 v1, s[12:15], s41 offen offset:2048 sc1 lds
    buffer_load_dwordx4 v1, s[12:15], s41 offen offset:3072 sc1 lds
    s_add_u32 m0, m0, 4096
    s_add_u32 s41, s41, 4096
    buffer_load_dwordx4 v1, s[12:15], s41 offen offset:0 sc1 lds
    buffer_load_dwordx4 v1, s[12:15], s41 offen offset:1024 sc1 lds
    buffer_load_dwordx4 v1, s[12:15], s41 offen offset:2048 sc1 lds
    buffer_load_dwordx4 v1, s[12:15], s41 offen offset:3072 sc1 lds
    s_add_u32 m0, m0, 4096
    s_add_u32 s41, s41, 4096
    buffer_load_dwordx4 v1, s[12:15], s41 offen offset:0 sc1 lds
    buffer_load_dwordx4 v1, s[12:15], s41 offen offset:1024 sc1 lds
    buffer_load_dwordx4 v1, s[12:15], s41 offen offset:2048 sc1 lds
    buffer_load_dwordx4 v1, s[12:15], s41 offen offset:3072 sc1 lds
    s_add_u32 m0, m0, 4096
    s_add_u32 s41, s41, 4096
    buffer_load_dwordx4 v1, s[12:15], s41 offen offset:0 sc1 lds
    buffer_load_dwordx4 v1, s[12:15], s41 offen offset:1024 sc1 lds
    buffer_load_dwordx4 v1, s[12:15], s41 offen offset:2048 sc1 lds
    buffer_load_dwordx4 v1, s[12:15], s41 offen offset:3072 sc1 lds
    s_add_u32 m0, m0, 4096
    s_add_u32 s41, s41, 4096
    buffer_load_dwordx4 v1, s[12:15], s41 offen offset:0 sc1 lds
    buffer_load_dwordx4 v1, s[12:15], s41 offen offset:1024 sc1 lds
    buffer_load_dwordx4 v1, s[12:15], s41 offen offset:2048 sc1 lds
    buffer_load_dwordx4 v1, s[12:15], s41 offen offset:3072 sc1 lds
    s_add_u32 m0, m0, 4096
    s_add_u32 s41, s41, 4096
    buffer_load_dwordx4 v1, s[12:15], s41 offen offset:0 sc1 lds
    buffer_load_dwordx4 v1, s[12:15], s41 offen offset:1024 sc1 lds
    buffer_load_dwordx4 v1, s[12:15], s41 offen offset:2048 sc1 lds
    buffer_load_dwordx4 v1, s[12:15], s41 offen offset:3072 sc1 lds
    s_add_u32 m0, m0, 4096
    s_add_u32 s41, s41, 4096
    buffer_load_dwordx4 v1, s[12:15], s41 offen offset:0 sc1 lds
    s_waitcnt vmcnt(0)
    s_barrier
    ds_read_b32 v15, v6
    s_waitcnt lgkmcnt(0)
    v_cmp_ne_u32 vcc, 0, v15
    s_cmp_eq_u64 vcc, 0
    s_cbranch_scc1 L_nsl_18
    s_barrier
    s_barrier
    s_barrier
    s_barrier
    s_and_b32 s30, s21, 7
    s_add_u32 s30, s30, 8
    s_mul_i32 s30, s30, 82944
    s_mul_i32 s31, s25, 40960
    s_add_u32 s41, s30, s31
    s_add_u32 s41, s41, 19406848
    s_mov_b32 m0, s31
    s_nop 0
    buffer_load_dwordx4 v1, s[12:15], s41 offen offset:0 sc1 lds
    buffer_load_dwordx4 v1, s[12:15], s41 offen offset:1024 sc1 lds
    buffer_load_dwordx4 v1, s[12:15], s41 offen offset:2048 sc1 lds
    buffer_load_dwordx4 v1, s[12:15], s41 offen offset:3072 sc1 lds
    s_add_u32 m0, m0, 4096
    s_add_u32 s41, s41, 4096
    buffer_load_dwordx4 v1, s[12:15], s41 offen offset:0 sc1 lds
    buffer_load_dwordx4 v1, s[12:15], s41 offen offset:1024 sc1 lds
    buffer_load_dwordx4 v1, s[12:15], s41 offen offset:2048 sc1 lds
    buffer_load_dwordx4 v1, s[12:15], s41 offen offset:3072 sc1 lds
    s_add_u32 m0, m0, 4096
    s_add_u32 s41, s41, 4096
    buffer_load_dwordx4 v1, s[12:15], s41 offen offset:0 sc1 lds
    buffer_load_dwordx4 v1, s[12:15], s41 offen offset:1024 sc1 lds
    buffer_load_dwordx4 v1, s[12:15], s41 offen offset:2048 sc1 lds
    buffer_load_dwordx4 v1, s[12:15], s41 offen offset:3072 sc1 lds
    s_add_u32 m0, m0, 4096
    s_add_u32 s41, s41, 4096
    buffer_load_dwordx4 v1, s[12:15], s41 offen offset:0 sc1 lds
    buffer_load_dwordx4 v1, s[12:15], s41 offen offset:1024 sc1 lds
    buffer_load_dwordx4 v1, s[12:15], s41 offen offset:2048 sc1 lds
    buffer_load_dwordx4 v1, s[12:15], s41 offen offset:3072 sc1 lds
    s_add_u32 m0, m0, 4096
    s_add_u32 s41, s41, 4096
    buffer_load_dwordx4 v1, s[12:15], s41 offen offset:0 sc1 lds
    buffer_load_dwordx4 v1, s[12:15], s41 offen offset:1024 sc1 lds
    buffer_load_dwordx4 v1, s[12:15], s41 offen offset:2048 sc1 lds
    buffer_load_dwordx4 v1, s[12:15], s41 offen offset:3072 sc1 lds
    s_add_u32 m0, m0, 4096
    s_add_u32 s41, s41, 4096
    buffer_load_dwordx4 v1, s[12:15], s41 offen offset:0 sc1 lds
    buffer_load_dwordx4 v1, s[12:15], s41 offen offset:1024 sc1 lds
    buffer_load_dwordx4 v1, s[12:15], s41 offen offset:2048 sc1 lds
    buffer_load_dwordx4 v1, s[12:15], s41 offen offset:3072 sc1 lds
    s_add_u32 m0, m0, 4096
    s_add_u32 s41, s41, 4096
    buffer_load_dwordx4 v1, s[12:15], s41 offen offset:0 sc1 lds
    buffer_load_dwordx4 v1, s[12:15], s41 offen offset:1024 sc1 lds
    buffer_load_dwordx4 v1, s[12:15], s41 offen offset:2048 sc1 lds
    buffer_load_dwordx4 v1, s[12:15], s41 offen offset:3072 sc1 lds
    s_add_u32 m0, m0, 4096
    s_add_u32 s41, s41, 4096
    buffer_load_dwordx4 v1, s[12:15], s41 offen offset:0 sc1 lds
    buffer_load_dwordx4 v1, s[12:15], s41 offen offset:1024 sc1 lds
    buffer_load_dwordx4 v1, s[12:15], s41 offen offset:2048 sc1 lds
    buffer_load_dwordx4 v1, s[12:15], s41 offen offset:3072 sc1 lds
    s_add_u32 m0, m0, 4096
    s_add_u32 s41, s41, 4096
    buffer_load_dwordx4 v1, s[12:15], s41 offen offset:0 sc1 lds
    buffer_load_dwordx4 v1, s[12:15], s41 offen offset:1024 sc1 lds
    buffer_load_dwordx4 v1, s[12:15], s41 offen offset:2048 sc1 lds
    buffer_load_dwordx4 v1, s[12:15], s41 offen offset:3072 sc1 lds
    s_add_u32 m0, m0, 4096
    s_add_u32 s41, s41, 4096
    buffer_load_dwordx4 v1, s[12:15], s41 offen offset:0 sc1 lds
    buffer_load_dwordx4 v1, s[12:15], s41 offen offset:1024 sc1 lds
    buffer_load_dwordx4 v1, s[12:15], s41 offen offset:2048 sc1 lds
    buffer_load_dwordx4 v1, s[12:15], s41 offen offset:3072 sc1 lds
    s_add_u32 m0, m0, 4096
    s_add_u32 s41, s41, 4096
    buffer_load_dwordx4 v1, s[12:15], s41 offen offset:0 sc1 lds
    s_waitcnt vmcnt(0)
    s_barrier
L_nsl_18:
    ds_write_b128 v2, v[16:19] offset:0
    ds_write_b128 v2, v[20:23] offset:1024
    ds_write_b128 v2, v[24:27] offset:2048
    ds_write_b128 v2, v[28:31] offset:3072
    ds_write_b128 v2, v[32:35] offset:4096
    ds_write_b128 v2, v[36:39] offset:5120
    ds_write_b128 v2, v[40:43] offset:6144
    ds_write_b128 v2, v[44:47] offset:7168
    ds_write_b128 v2, v[48:51] offset:8192
    s_waitcnt lgkmcnt(0)
    s_barrier
    s_mov_b32 s47, 0
    s_mul_i32 s30, s25, 36864
    s_add_u32 s30, s30, 82944
    s_barrier
    buffer_load_dword v7, v5, s[12:15], s34 offen sc1
L_bpl_19:
    s_waitcnt vmcnt(0)
    v_cmp_eq_u32 vcc, v7, v3
    s_cmp_eq_u64 vcc, -1
    s_cbranch_scc1 L_bpd_20
    buffer_load_dword v7, v5, s[12:15], s34 offen sc1
    s_add_u32 s47, s47, 1
    s_cmp_lt_u32 s47, 65536
    s_cbranch_scc1 L_bpl_19
L_bpd_20:
    s_mov_b32 m0, s30
    s_nop 0
    buffer_load_dwordx4 v1, s[12:15], s38 offen offset:0 sc1 lds
    buffer_load_dwordx4 v1, s[12:15], s38 offen offset:1024 sc1 lds
    buffer_load_dwordx4 v1, s[12:15], s38 offen offset:2048 sc1 lds
    buffer_load_dwordx4 v1, s[12:15], s38 offen offset:3072 sc1 lds
    s_add_u32 m0, m0, 4096
    s_add_u32 s38, s38, 4096
    buffer_load_dwordx4 v1, s[12:15], s38 offen offset:0 sc1 lds
    buffer_load_dwordx4 v1, s[12:15], s38 offen offset:1024 sc1 lds
    buffer_load_dwordx4 v1, s[12:15], s38 offen offset:2048 sc1 lds
    buffer_load_dwordx4 v1, s[12:15], s38 offen offset:3072 sc1 lds
    s_add_u32 m0, m0, 4096
    s_add_u32 s38, s38, 4096
    buffer_load_dwordx4 v1, s[12:15], s38 offen offset:0 sc1 lds
    buffer_load_dwordx4 v1, s[12:15], s38 offen offset:1024 sc1 lds
    buffer_load_dwordx4 v1, s[12:15], s38 offen offset:2048 sc1 lds
    buffer_load_dwordx4 v1, s[12:15], s38 offen offset:3072 sc1 lds
    s_add_u32 m0, m0, 4096
    s_add_u32 s38, s38, 4096
    buffer_load_dwordx4 v1, s[12:15], s38 offen offset:0 sc1 lds
    buffer_load_dwordx4 v1, s[12:15], s38 offen offset:1024 sc1 lds
    buffer_load_dwordx4 v1, s[12:15], s38 offen offset:2048 sc1 lds
    buffer_load_dwordx4 v1, s[12:15], s38 offen offset:3072 sc1 lds
    s_add_u32 m0, m0, 4096
    s_add_u32 s38, s38, 4096
    buffer_load_dwordx4 v1, s[12:15], s38 offen offset:0 sc1 lds
    buffer_load_dwordx4 v1, s[12:15], s38 offen offset:1024 sc1 lds
    buffer_load_dwordx4 v1, s[12:15], s38 offen offset:2048 sc1 lds
    buffer_load_dwordx4 v1, s[12:15], s38 offen offset:3072 sc1 lds
    s_add_u32 m0, m0, 4096
    s_add_u32 s38, s38, 4096
    buffer_load_dwordx4 v1, s[12:15], s38 offen offset:0 sc1 lds
    buffer_load_dwordx4 v1, s[12:15], s38 offen offset:1024 sc1 lds
    buffer_load_dwordx4 v1, s[12:15], s38 offen offset:2048 sc1 lds
    buffer_load_dwordx4 v1, s[12:15], s38 offen offset:3072 sc1 lds
    s_add_u32 m0, m0, 4096
    s_add_u32 s38, s38, 4096
    buffer_load_dwordx4 v1, s[12:15], s38 offen offset:0 sc1 lds
    buffer_load_dwordx4 v1, s[12:15], s38 offen offset:1024 sc1 lds
    buffer_load_dwordx4 v1, s[12:15], s38 offen offset:2048 sc1 lds
    buffer_load_dwordx4 v1, s[12:15], s38 offen offset:3072 sc1 lds
    s_add_u32 m0, m0, 4096
    s_add_u32 s38, s38, 4096
    buffer_load_dwordx4 v1, s[12:15], s38 offen offset:0 sc1 lds
    buffer_load_dwordx4 v1, s[12:15], s38 offen offset:1024 sc1 lds
    buffer_load_dwordx4 v1, s[12:15], s38 offen offset:2048 sc1 lds
    buffer_load_dwordx4 v1, s[12:15], s38 offen offset:3072 sc1 lds
    s_add_u32 m0, m0, 4096
    s_add_u32 s38, s38, 4096
    buffer_load_dwordx4 v1, s[12:15], s38 offen offset:0 sc1 lds
    buffer_load_dwordx4 v1, s[12:15], s38 offen offset:1024 sc1 lds
    buffer_load_dwordx4 v1, s[12:15], s38 offen offset:2048 sc1 lds
    buffer_load_dwordx4 v1, s[12:15], s38 offen offset:3072 sc1 lds
    s_waitcnt vmcnt(28)
    s_barrier
    s_waitcnt vmcnt(20)
    s_barrier
    s_waitcnt vmcnt(12)
    s_barrier
    s_waitcnt vmcnt(6)
    s_barrier
    s_waitcnt vmcnt(2)
    s_barrier
    s_waitcnt vmcnt(0)
    s_barrier
    s_endpgm
L_f3_kernel_helper:
    s_setprio 0
    s_sub_u32 s25, s20, 10
    v_lshlrev_b32 v1, 4, v0
    v_lshrrev_b32 v9, 4, v0
    v_lshlrev_b32 v9, 6, v9
    s_mul_i32 s30, s25, 9216
    s_add_u32 s30, s30, 125952
    v_add_u32 v2, s30, v1
    s_waitcnt lgkmcnt(0)
    s_mov_b32 s14, 20733952
    s_mov_b32 s15, 0x00020000
    s_mov_b32 s16, s54
    s_mov_b32 s17, s55
    s_mov_b32 s18, 256
    s_mov_b32 s19, 0x00020000
    s_lshr_b32 s26, s21, 1
    s_and_b32 s26, s26, 1
    s_lshl_b32 s26, s26, 3
    s_and_b32 s33, s21, 1
    s_lshl_b32 s27, s33, 3
    s_add_u32 s31, s26, s27
    s_xor_b32 s27, s33, 1
    s_lshl_b32 s27, s27, 5
    s_add_u32 s32, s26, s27
    v_and_b32 v3, 15, v0
    v_lshrrev_b32 v4, 4, v0
    v_lshrrev_b32 v5, 1, v3
    v_xor_b32 v5, v5, v4
    v_and_b32 v5, 7, v5
    v_lshlrev_b32 v5, 4, v5
    v_lshl_add_u32 v48, v3, 7, v5
    v_xor_b32 v49, 64, v48
    v_bfe_u32 v5, v0, 2, 2
    v_mul_u32_u24 v5, 192, v5
    v_lshrrev_b32 v6, 1, v4
    v_mul_u32_u24 v6, 768, v6
    v_and_b32 v7, 1, v4
    v_mul_u32_u24 v7, 96, v7
    v_add3_u32 v5, v5, v6, v7
    v_and_b32 v6, 3, v0
    v_lshlrev_b32 v7, 3, v6
    s_mul_i32 s28, s25, 3088
    s_add_u32 s28, s28, s31
    s_add_u32 s28, s28, 37904
    v_add3_u32 v50, v5, v7, s28
    v_and_b32 v6, 1, v6
    v_mul_u32_u24 v6, 3088, v6
    s_add_u32 s28, s32, 37904
    v_add3_u32 v51, v5, v6, s28
    v_lshrrev_b32 v5, 1, v4
    v_lshlrev_b32 v6, 2, v5
    v_xor_b32 v6, v6, v3
    v_lshlrev_b32 v6, 4, v6
    v_lshl_add_u32 v6, v5, 9, v6
    v_and_b32 v7, 1, v4
    v_lshl_add_u32 v6, v7, 3, v6
    s_cmp_eq_u32 s25, 1
    s_cselect_b32 s28, 1024, 0
    s_add_u32 s28, s28, 58368
    v_add_u32 v52, s28, v6
    v_lshlrev_b32 v5, 2, v3
    v_add_u32 v5, 60672, v5
    v_lshlrev_b32 v7, 3, v3
    v_add_u32 v7, 60416, v7
    v_cmp_eq_u32 vcc, 0, v4
    s_nop 1
    v_cndmask_b32 v53, v7, v5, vcc
    v_mov_b32 v16, 0
    v_mov_b32 v17, 0
    v_mov_b32 v18, 0
    v_mov_b32 v19, 0
    v_mov_b32 v20, 0
    v_mov_b32 v21, 0
    v_mov_b32 v22, 0
    v_mov_b32 v23, 0
    s_barrier
    s_barrier
    s_lshl_b32 s38, s22, 3
    s_lshl_b32 s39, s25, 2
    s_add_u32 s38, s38, s39
    s_mul_i32 s38, s38, 36864
    s_add_u32 s38, s38, 17047552
    s_lshl_b32 s39, s21, 7
    s_add_u32 s39, s39, s38
    s_lshl_b32 s40, s21, 10
    s_add_u32 s38, s38, s40
    s_add_u32 s38, s38, 4096
    v_and_b32 v59, 31, v0
    v_lshlrev_b32 v59, 2, v59
    v_mov_b32 v60, -1
    v_mov_b32 v61, -1
    v_mov_b32 v62, -1
    v_mov_b32 v63, -1
    s_mov_b32 s26, 0
    s_mov_b32 s27, 0
L_hl_21:
    s_barrier
    ds_read_b128 v[24:27], v48
    ds_read_b64_tr_b16 v[32:33], v50 offset:0
    ds_read_b64_tr_b16 v[34:35], v50 offset:48
    ds_read_b128 v[28:31], v49
    ds_read_b64_tr_b16 v[36:37], v50 offset:1536
    ds_read_b64_tr_b16 v[38:39], v50 offset:1584
    s_cmp_lg_u32 s25, 0
    s_cbranch_scc1 L_h1_22
    ds_read_b64_tr_b16 v[40:41], v51 offset:0
    ds_read_b64_tr_b16 v[42:43], v51 offset:48
    ds_read_b64_tr_b16 v[44:45], v51 offset:1536
    ds_read_b64_tr_b16 v[46:47], v51 offset:1584
    s_waitcnt lgkmcnt(0)
    v_mfma_f32_16x16x32_bf16 v[20:23], v[40:43], v[24:27], v[20:23]
    v_mfma_f32_16x16x32_bf16 v[16:19], v[32:35], v[24:27], v[16:19]
    v_mfma_f32_16x16x32_bf16 v[20:23], v[44:47], v[28:31], v[20:23]
    v_mfma_f32_16x16x32_bf16 v[16:19], v[36:39], v[28:31], v[16:19]
    s_branch L_h2_23
L_h1_22:
    s_waitcnt lgkmcnt(0)
    v_mfma_f32_16x16x32_bf16 v[16:19], v[32:35], v[24:27], v[16:19]
    v_mfma_f32_16x16x32_bf16 v[16:19], v[36:39], v[28:31], v[16:19]
L_h2_23:
    s_cmp_lg_u32 s26, 5
    s_cbranch_scc1 L_dfs_25
    buffer_store_dwordx4 v[60:63], v1, s[12:15], s38 offen sc1
    buffer_store_dword v60, v59, s[12:15], s39 offen sc1
    s_add_u32 s38, s38, 36864
    s_add_u32 s39, s39, 36864
    buffer_store_dwordx4 v[60:63], v1, s[12:15], s38 offen sc1
    buffer_store_dword v60, v59, s[12:15], s39 offen sc1
    s_add_u32 s38, s38, 36864
    s_add_u32 s39, s39, 36864
    buffer_store_dwordx4 v[60:63], v1, s[12:15], s38 offen sc1
    buffer_store_dword v60, v59, s[12:15], s39 offen sc1
    s_add_u32 s38, s38, 36864
    s_add_u32 s39, s39, 36864
    buffer_store_dwordx4 v[60:63], v1, s[12:15], s38 offen sc1
    buffer_store_dword v60, v59, s[12:15], s39 offen sc1
    s_add_u32 s38, s38, 36864
    s_add_u32 s39, s39, 36864
L_dfs_25:
    s_add_u32 s27, s27, 53376
    s_cmp_eq_u32 s27, 160128
    s_mov_b32 s28, 53376
    s_cselect_b32 s28, 4294860544, s28
    s_cselect_b32 s27, 0, s27
    v_add_u32 v48, s28, v48
    v_add_u32 v49, s28, v49
    v_add_u32 v50, s28, v50
    v_add_u32 v51, s28, v51
    s_add_u32 s26, s26, 1
    s_cmp_lt_u32 s26, 9
    s_cbranch_scc1 L_hl_21
    v_cvt_pk_bf16_f32 v16, v16, v17
    v_cvt_pk_bf16_f32 v17, v18, v19
    ds_write_b64 v52, v[16:17]
    ds_write_b64 v52, v[16:17] offset:256
    s_cmp_lg_u32 s25, 0
    s_cbranch_scc1 L_h3_24
    s_cmp_eq_u32 s33, 1
    s_cselect_b64 vcc, -1, 0
    v_cndmask_b32 v20, v20, v22, vcc
    v_cndmask_b32 v21, v21, v23, vcc
    v_cvt_pk_bf16_f32 v20, v20, v21
    v_mov_b32 v21, 0x3f80
    s_mov_b32 exec_lo, 0xffff
    s_mov_b32 exec_hi, 0
    ds_write_b32 v53, v20
    ds_write_b32 v53, v20 offset:64
    s_mov_b32 exec_lo, 0xffff0000
    ds_write_b64 v53, v[20:21]
    ds_write_b64 v53, v[20:21] offset:128
    s_mov_b64 exec, -1
L_h3_24:
    s_waitcnt lgkmcnt(0)
    s_waitcnt vmcnt(0)
    s_barrier
    s_barrier
    s_barrier
    s_barrier
    s_mov_b32 s47, 0
    s_mov_b32 s34, 32768
L_apl_26:
    buffer_load_dword v11, v9, s[16:19], 0 offen sc1
    buffer_load_dwordx4 v[12:15], v1, s[12:15], s34 offen sc1
    s_add_u32 s47, s47, 1
    s_cmp_ge_u32 s47, 65536
    s_cbranch_scc1 L_apd_27
    s_waitcnt vmcnt(0)
    v_cmp_ne_u32 s[36:37], 0, v11
    v_cmp_eq_u32 vcc, v12, v11
    s_and_b64 s[36:37], s[36:37], vcc
    v_cmp_eq_u32 vcc, v13, v11
    s_and_b64 s[36:37], s[36:37], vcc
    v_cmp_eq_u32 vcc, v14, v11
    s_and_b64 s[36:37], s[36:37], vcc
    v_cmp_eq_u32 vcc, v15, v11
    s_and_b64 s[36:37], s[36:37], vcc
    s_cmp_eq_u64 s[36:37], -1
    s_cbranch_scc0 L_apl_26
L_apd_27:
    s_waitcnt vmcnt(0)
    s_setprio 0
    s_lshr_b32 s40, s21, 3
    s_lshl_b32 s40, s40, 1
    s_add_u32 s40, s40, s25
    s_lshl_b32 s30, s22, 3
    s_add_u32 s40, s40, s30
    s_mul_i32 s40, s40, 36864
    s_add_u32 s38, s40, 14704640
    s_and_b32 s30, s21, 7
    s_mul_i32 s30, s30, 82944
    s_add_u32 s39, s30, 19448320
    v_lshrrev_b32 v6, 5, v0
    v_lshlrev_b32 v6, 7, v6
    v_and_b32 v7, 7, v0
    v_lshl_add_u32 v4, v7, 4, v6
    v_and_b32 v6, 24, v0
    v_mov_b32 v7, 268435456
    v_cmp_ne_u32 vcc, 0, v6
    s_nop 1
    v_cndmask_b32 v4, v4, v7, vcc
    buffer_load_dwordx4 v[64:67], v1, s[12:15], s38 offen offset:2048 sc1
    buffer_load_dwordx4 v[68:71], v1, s[12:15], s39 offen
    buffer_load_dwordx4 v[72:75], v1, s[12:15], s39 offen offset:1024
    buffer_load_dwordx4 v[76:79], v4, s[12:15], s39 offen offset:2048
    s_add_u32 s39, s39, 2304
    buffer_load_dwordx4 v[80:83], v1, s[12:15], s38 offen offset:3072 sc1
    buffer_load_dwordx4 v[84:87], v1, s[12:15], s39 offen
    buffer_load_dwordx4 v[88:91], v1, s[12:15], s39 offen offset:1024
    buffer_load_dwordx4 v[92:95], v4, s[12:15], s39 offen offset:2048
    s_add_u32 s39, s39, 2304
    s_add_u32 s38, s38, 4096
    buffer_load_dwordx4 v[96:99], v1, s[12:15], s38 offen offset:0 sc1
    buffer_load_dwordx4 v[100:103], v1, s[12:15], s39 offen
    buffer_load_dwordx4 v[104:107], v1, s[12:15], s39 offen offset:1024
    buffer_load_dwordx4 v[108:111], v4, s[12:15], s39 offen offset:2048
    s_add_u32 s39, s39, 2304
    buffer_load_dwordx4 v[112:115], v1, s[12:15], s38 offen offset:1024 sc1
    buffer_load_dwordx4 v[116:119], v1, s[12:15], s39 offen
    buffer_load_dwordx4 v[120:123], v1, s[12:15], s39 offen offset:1024
    buffer_load_dwordx4 v[124:127], v4, s[12:15], s39 offen offset:2048
    s_add_u32 s39, s39, 2304
    buffer_load_dwordx4 v[128:131], v1, s[12:15], s38 offen offset:2048 sc1
    buffer_load_dwordx4 v[132:135], v1, s[12:15], s39 offen
    buffer_load_dwordx4 v[136:139], v1, s[12:15], s39 offen offset:1024
    buffer_load_dwordx4 v[140:143], v4, s[12:15], s39 offen offset:2048
    s_add_u32 s39, s39, 2304
    buffer_load_dwordx4 v[144:147], v1, s[12:15], s38 offen offset:3072 sc1
    buffer_load_dwordx4 v[148:151], v1, s[12:15], s39 offen
    buffer_load_dwordx4 v[152:155], v1, s[12:15], s39 offen offset:1024
    buffer_load_dwordx4 v[156:159], v4, s[12:15], s39 offen offset:2048
    s_add_u32 s39, s39, 2304
    s_add_u32 s38, s38, 4096
    s_waitcnt vmcnt(20)
    v_mfma_f32_32x32x16_bf16 v[16:31], v[68:71], v[64:67], 0
    v_mfma_f32_32x32x16_bf16 v[32:47], v[72:75], v[64:67], 0
    v_mfma_f32_32x32x16_bf16 v[48:63], v[76:79], v[64:67], 0
    buffer_load_dwordx4 v[64:67], v1, s[12:15], s38 offen offset:0 sc1
    buffer_load_dwordx4 v[68:71], v1, s[12:15], s39 offen
    buffer_load_dwordx4 v[72:75], v1, s[12:15], s39 offen offset:1024
    buffer_load_dwordx4 v[76:79], v4, s[12:15], s39 offen offset:2048
    s_add_u32 s39, s39, 2304
    s_waitcnt vmcnt(20)
    v_mfma_f32_32x32x16_bf16 v[16:31], v[84:87], v[80:83], v[16:31]
    v_mfma_f32_32x32x16_bf16 v[32:47], v[88:91], v[80:83], v[32:47]
    v_mfma_f32_32x32x16_bf16 v[48:63], v[92:95], v[80:83], v[48:63]
    buffer_load_dwordx4 v[80:83], v1, s[12:15], s38 offen offset:1024 sc1
    buffer_load_dwordx4 v[84:87], v1, s[12:15], s39 offen
    buffer_load_dwordx4 v[88:91], v1, s[12:15], s39 offen offset:1024
    buffer_load_dwordx4 v[92:95], v4, s[12:15], s39 offen offset:2048
    s_add_u32 s39, s39, 2304
    s_waitcnt vmcnt(20)
    v_mfma_f32_32x32x16_bf16 v[16:31], v[100:103], v[96:99], v[16:31]
    v_mfma_f32_32x32x16_bf16 v[32:47], v[104:107], v[96:99], v[32:47]
    v_mfma_f32_32x32x16_bf16 v[48:63], v[108:111], v[96:99], v[48:63]
    buffer_load_dwordx4 v[96:99], v1, s[12:15], s38 offen offset:2048 sc1
    buffer_load_dwordx4 v[100:103], v1, s[12:15], s39 offen
    buffer_load_dwordx4 v[104:107], v1, s[12:15], s39 offen offset:1024
    buffer_load_dwordx4 v[108:111], v4, s[12:15], s39 offen offset:2048
    s_add_u32 s39, s39, 2304
    s_waitcnt vmcnt(20)
    v_mfma_f32_32x32x16_bf16 v[16:31], v[116:119], v[112:115], v[16:31]
    v_mfma_f32_32x32x16_bf16 v[32:47], v[120:123], v[112:115], v[32:47]
    v_mfma_f32_32x32x16_bf16 v[48:63], v[124:127], v[112:115], v[48:63]
    buffer_load_dwordx4 v[112:115], v1, s[12:15], s38 offen offset:3072 sc1
    buffer_load_dwordx4 v[116:119], v1, s[12:15], s39 offen
    buffer_load_dwordx4 v[120:123], v1, s[12:15], s39 offen offset:1024
    buffer_load_dwordx4 v[124:127], v4, s[12:15], s39 offen offset:2048
    s_add_u32 s39, s39, 2304
    s_add_u32 s38, s38, 4096
    s_barrier
    s_waitcnt vmcnt(20)
    v_mfma_f32_32x32x16_bf16 v[16:31], v[132:135], v[128:131], v[16:31]
    v_mfma_f32_32x32x16_bf16 v[32:47], v[136:139], v[128:131], v[32:47]
    v_mfma_f32_32x32x16_bf16 v[48:63], v[140:143], v[128:131], v[48:63]
    buffer_load_dwordx4 v[128:131], v1, s[12:15], s38 offen offset:0 sc1
    buffer_load_dwordx4 v[132:135], v1, s[12:15], s39 offen
    buffer_load_dwordx4 v[136:139], v1, s[12:15], s39 offen offset:1024
    buffer_load_dwordx4 v[140:143], v4, s[12:15], s39 offen offset:2048
    s_add_u32 s39, s39, 2304
    s_waitcnt vmcnt(20)
    v_mfma_f32_32x32x16_bf16 v[16:31], v[148:151], v[144:147], v[16:31]
    v_mfma_f32_32x32x16_bf16 v[32:47], v[152:155], v[144:147], v[32:47]
    v_mfma_f32_32x32x16_bf16 v[48:63], v[156:159], v[144:147], v[48:63]
    buffer_load_dwordx4 v[144:147], v1, s[12:15], s38 offen offset:1024 sc1
    buffer_load_dwordx4 v[148:151], v1, s[12:15], s39 offen
    buffer_load_dwordx4 v[152:155], v1, s[12:15], s39 offen offset:1024
    buffer_load_dwordx4 v[156:159], v4, s[12:15], s39 offen offset:2048
    s_add_u32 s39, s39, 2304
    s_waitcnt vmcnt(20)
    v_mfma_f32_32x32x16_bf16 v[16:31], v[68:71], v[64:67], v[16:31]
    v_mfma_f32_32x32x16_bf16 v[32:47], v[72:75], v[64:67], v[32:47]
    v_mfma_f32_32x32x16_bf16 v[48:63], v[76:79], v[64:67], v[48:63]
    buffer_load_dwordx4 v[64:67], v1, s[12:15], s38 offen offset:2048 sc1
    buffer_load_dwordx4 v[68:71], v1, s[12:15], s39 offen
    buffer_load_dwordx4 v[72:75], v1, s[12:15], s39 offen offset:1024
    buffer_load_dwordx4 v[76:79], v4, s[12:15], s39 offen offset:2048
    s_add_u32 s39, s39, 2304
    s_waitcnt vmcnt(20)
    v_mfma_f32_32x32x16_bf16 v[16:31], v[84:87], v[80:83], v[16:31]
    v_mfma_f32_32x32x16_bf16 v[32:47], v[88:91], v[80:83], v[32:47]
    v_mfma_f32_32x32x16_bf16 v[48:63], v[92:95], v[80:83], v[48:63]
    buffer_load_dwordx4 v[80:83], v1, s[12:15], s38 offen offset:3072 sc1
    buffer_load_dwordx4 v[84:87], v1, s[12:15], s39 offen
    buffer_load_dwordx4 v[88:91], v1, s[12:15], s39 offen offset:1024
    buffer_load_dwordx4 v[92:95], v4, s[12:15], s39 offen offset:2048
    s_add_u32 s39, s39, 2304
    s_add_u32 s38, s38, 4096
    s_waitcnt vmcnt(20)
    v_mfma_f32_32x32x16_bf16 v[16:31], v[100:103], v[96:99], v[16:31]
    v_mfma_f32_32x32x16_bf16 v[32:47], v[104:107], v[96:99], v[32:47]
    v_mfma_f32_32x32x16_bf16 v[48:63], v[108:111], v[96:99], v[48:63]
    buffer_load_dwordx4 v[96:99], v1, s[12:15], s38 offen offset:0 sc1
    buffer_load_dwordx4 v[100:103], v1, s[12:15], s39 offen
    buffer_load_dwordx4 v[104:107], v1, s[12:15], s39 offen offset:1024
    buffer_load_dwordx4 v[108:111], v4, s[12:15], s39 offen offset:2048
    s_add_u32 s39, s39, 2304
    s_waitcnt vmcnt(20)
    v_mfma_f32_32x32x16_bf16 v[16:31], v[116:119], v[112:115], v[16:31]
    v_mfma_f32_32x32x16_bf16 v[32:47], v[120:123], v[112:115], v[32:47]
    v_mfma_f32_32x32x16_bf16 v[48:63], v[124:127], v[112:115], v[48:63]
    buffer_load_dwordx4 v[112:115], v1, s[12:15], s38 offen offset:1024 sc1
    buffer_load_dwordx4 v[116:119], v1, s[12:15], s39 offen
    buffer_load_dwordx4 v[120:123], v1, s[12:15], s39 offen offset:1024
    buffer_load_dwordx4 v[124:127], v4, s[12:15], s39 offen offset:2048
    s_add_u32 s39, s39, 2304
    s_waitcnt vmcnt(20)
    v_mfma_f32_32x32x16_bf16 v[16:31], v[132:135], v[128:131], v[16:31]
    v_mfma_f32_32x32x16_bf16 v[32:47], v[136:139], v[128:131], v[32:47]
    v_mfma_f32_32x32x16_bf16 v[48:63], v[140:143], v[128:131], v[48:63]
    buffer_load_dwordx4 v[128:131], v1, s[12:15], s38 offen offset:2048 sc1
    buffer_load_dwordx4 v[132:135], v1, s[12:15], s39 offen
    buffer_load_dwordx4 v[136:139], v1, s[12:15], s39 offen offset:1024
    buffer_load_dwordx4 v[140:143], v4, s[12:15], s39 offen offset:2048
    s_add_u32 s39, s39, 2304
    s_waitcnt vmcnt(20)
    v_mfma_f32_32x32x16_bf16 v[16:31], v[148:151], v[144:147], v[16:31]
    v_mfma_f32_32x32x16_bf16 v[32:47], v[152:155], v[144:147], v[32:47]
    v_mfma_f32_32x32x16_bf16 v[48:63], v[156:159], v[144:147], v[48:63]
    buffer_load_dwordx4 v[144:147], v1, s[12:15], s38 offen offset:3072 sc1
    buffer_load_dwordx4 v[148:151], v1, s[12:15], s39 offen
    buffer_load_dwordx4 v[152:155], v1, s[12:15], s39 offen offset:1024
    buffer_load_dwordx4 v[156:159], v4, s[12:15], s39 offen offset:2048
    s_add_u32 s39, s39, 2304
    s_add_u32 s38, s38, 4096
    s_waitcnt vmcnt(20)
    v_mfma_f32_32x32x16_bf16 v[16:31], v[68:71], v[64:67], v[16:31]
    v_mfma_f32_32x32x16_bf16 v[32:47], v[72:75], v[64:67], v[32:47]
    v_mfma_f32_32x32x16_bf16 v[48:63], v[76:79], v[64:67], v[48:63]
    s_waitcnt vmcnt(16)
    v_mfma_f32_32x32x16_bf16 v[16:31], v[84:87], v[80:83], v[16:31]
    v_mfma_f32_32x32x16_bf16 v[32:47], v[88:91], v[80:83], v[32:47]
    v_mfma_f32_32x32x16_bf16 v[48:63], v[92:95], v[80:83], v[48:63]
    s_waitcnt vmcnt(12)
    v_mfma_f32_32x32x16_bf16 v[16:31], v[100:103], v[96:99], v[16:31]
    v_mfma_f32_32x32x16_bf16 v[32:47], v[104:107], v[96:99], v[32:47]
    v_mfma_f32_32x32x16_bf16 v[48:63], v[108:111], v[96:99], v[48:63]
    s_waitcnt vmcnt(8)
    v_mfma_f32_32x32x16_bf16 v[16:31], v[116:119], v[112:115], v[16:31]
    v_mfma_f32_32x32x16_bf16 v[32:47], v[120:123], v[112:115], v[32:47]
    v_mfma_f32_32x32x16_bf16 v[48:63], v[124:127], v[112:115], v[48:63]
    s_waitcnt vmcnt(4)
    v_mfma_f32_32x32x16_bf16 v[16:31], v[132:135], v[128:131], v[16:31]
    v_mfma_f32_32x32x16_bf16 v[32:47], v[136:139], v[128:131], v[32:47]
    v_mfma_f32_32x32x16_bf16 v[48:63], v[140:143], v[128:131], v[48:63]
    s_waitcnt vmcnt(0)
    v_mfma_f32_32x32x16_bf16 v[16:31], v[148:151], v[144:147], v[16:31]
    v_mfma_f32_32x32x16_bf16 v[32:47], v[152:155], v[144:147], v[32:47]
    v_mfma_f32_32x32x16_bf16 v[48:63], v[156:159], v[144:147], v[48:63]
    v_and_b32 v6, 7, v0
    v_lshlrev_b32 v6, 2, v6
    v_add_u32 v6, 155648, v6
    s_barrier
    s_barrier
    ds_read_b32 v15, v6
    s_waitcnt lgkmcnt(0)
    v_cmp_ne_u32 vcc, 0, v15
    s_cmp_eq_u64 vcc, 0
    s_cbranch_scc1 L_hns_28
    s_barrier
    s_barrier
    s_barrier
    s_barrier
    s_barrier
L_hns_28:
    ds_write_b128 v2, v[16:19] offset:0
    ds_write_b128 v2, v[20:23] offset:1024
    ds_write_b128 v2, v[24:27] offset:2048
    ds_write_b128 v2, v[28:31] offset:3072
    ds_write_b128 v2, v[32:35] offset:4096
    ds_write_b128 v2, v[36:39] offset:5120
    ds_write_b128 v2, v[40:43] offset:6144
    ds_write_b128 v2, v[44:47] offset:7168
    ds_write_b128 v2, v[48:51] offset:8192
    s_waitcnt lgkmcnt(0)
    s_barrier
    s_barrier
    s_barrier
    s_barrier
    s_barrier
    s_barrier
    s_barrier
    s_barrier
    s_endpgm
L_f3_kernel_compute:
    s_setprio 2
    s_and_b32 s26, s21, 7
    s_lshl_b32 s26, s26, 3
    s_add_u32 s34, s26, s22
    s_lshr_b32 s26, s34, 1
    s_lshl_b32 s26, s26, 3
    s_and_b32 s27, s34, 1
    s_add_u32 s26, s26, s27
    s_add_u32 s26, s26, 64
    s_mul_i32 s35, s26, 6912
    s_lshr_b32 s26, s20, 1
    s_mul_i32 s26, s26, 1152
    s_add_u32 s35, s35, s26
    s_lshr_b32 s26, s21, 3
    s_mul_i32 s26, s26, 288
    s_add_u32 s35, s35, s26
    s_cmp_lt_u32 s20, 6
    s_cselect_b32 s43, 1, 0
    s_cmp_lt_u32 s34, 56
    s_cselect_b32 s43, s43, 0
    s_mul_i32 s29, s20, 2304
    s_add_u32 s29, s29, 106752
    s_movk_i32 s26, 3641
    s_movk_i32 s27, 3456
    v_add_u32 v6, 0, v0
    v_mul_u32_u24 v7, s26, v6
    v_lshrrev_b32 v7, 16, v7
    v_mul_u32_u24 v8, 18, v7
    v_sub_u32 v8, v6, v8
    v_and_b32 v9, 3, v7
    v_lshrrev_b32 v7, 2, v7
    v_lshl_add_u32 v7, v9, 2, v7
    v_lshlrev_b32 v8, 4, v8
    v_mad_u32_u24 v3, v7, s27, v8
    v_add_u32 v6, 64, v0
    v_mul_u32_u24 v7, s26, v6
    v_lshrrev_b32 v7, 16, v7
    v_mul_u32_u24 v8, 18, v7
    v_sub_u32 v8, v6, v8
    v_and_b32 v9, 3, v7
    v_lshrrev_b32 v7, 2, v7
    v_lshl_add_u32 v7, v9, 2, v7
    v_lshlrev_b32 v8, 4, v8
    v_mad_u32_u24 v4, v7, s27, v8
    v_lshlrev_b32 v8, 4, v0
    v_add_u32 v5, 44960, v8
    s_and_b32 s27, s20, 1
    s_cmp_eq_u32 s27, 0
    s_waitcnt lgkmcnt(0)
    s_cselect_b32 s8, s8, s48
    s_cselect_b32 s9, s9, s49
    s_mov_b32 s10, 1990656
    s_mov_b32 s11, 0x00020000
    s_cmp_eq_u32 s43, 0
    s_cbranch_scc1 L_ng_30
    s_mov_b32 m0, s29
    s_nop 0
    buffer_load_dwordx4 v3, s[8:11], s35 offen lds
    s_add_u32 m0, s29, 1024
    s_nop 0
    buffer_load_dwordx4 v4, s[8:11], s35 offen lds
    s_add_u32 m0, s29, 2048
    s_mov_b64 exec, 0xffff
    buffer_load_dwordx4 v5, s[8:11], s35 offen lds
    s_mov_b64 exec, -1
L_ng_30:
    s_mov_b32 s16, 0xffffffff
    s_mov_b32 s17, 0xf
    s_cmp_lg_u32 s20, 6
    s_cbranch_scc1 L_n6_31
    s_and_b32 s26, s21, 7
    s_lshl_b32 s26, s26, 2
    s_and_b32 s27, s22, 3
    s_add_u32 s26, s26, s27
    s_mul_i32 s26, s26, 6912
    s_lshr_b32 s27, s21, 3
    s_lshl_b32 s27, s27, 8
    s_add_u32 s26, s26, s27
    s_movk_i32 s27, 7282
    s_movk_i32 s28, 21846
    v_mul_u32_u24 v6, s27, v0
    v_lshrrev_b32 v6, 16, v6
    v_mul_u32_u24 v7, 9, v6
    v_sub_u32 v7, v0, v7
    v_mul_u32_u24 v8, s28, v7
    v_lshrrev_b32 v8, 16, v8
    v_mul_u32_u24 v9, 3, v8
    v_sub_u32 v7, v7, v9
    v_lshrrev_b32 v9, 1, v6
    v_and_b32 v6, 1, v6
    v_lshl_add_u32 v6, v9, 6, v6
    s_movk_i32 s27, 3456
    s_movk_i32 s28, 1152
    v_mul_u32_u24 v6, s27, v6
    v_mad_u32_u24 v6, v8, s28, v6
    v_lshl_add_u32 v6, v7, 7, v6
    s_mov_b64 exec, s[16:17]
    buffer_load_dword v15, v6, s[8:11], s26 offen
    s_mov_b32 s8, s48
    s_mov_b32 s9, s49
    buffer_load_dword v15, v6, s[8:11], s26 offen
    s_mov_b64 exec, -1
L_n6_31:
    s_cmp_lg_u32 s20, 7
    s_cbranch_scc1 L_nn_29
    s_mov_b32 s16, s54
    s_mov_b32 s17, s55
    s_mov_b32 s18, 256
    s_mov_b32 s19, 0x00020000
    s_or_b32 s40, s14, 1
    v_mov_b32 v3, 0
    v_mov_b32 v15, 0
    v_mov_b32 v14, s40
    s_lshr_b32 s28, s21, 3
    s_lshl_b32 s28, s28, 6
    s_mov_b64 exec, 1
    buffer_atomic_cmpswap v[14:15], v3, s[16:19], s28 offen sc0 sc1
    s_mov_b64 exec, 3
    v_lshl_add_u32 v4, v0, 2, 0
    v_add_u32 v4, 160132, v4
    ds_write_b32 v4, v3
    s_mov_b64 exec, -1
    s_and_b32 s26, s21, 7
    s_mul_i32 s26, s26, 34
    s_lshl_b32 s27, s22, 8
    s_add_u32 s26, s26, s27
    s_sub_u32 s26, s26, 16
    s_mul_i32 s26, s26, 1152
    s_mov_b32 s16, s4
    s_mov_b32 s17, s5
    s_mov_b32 s18, 2359296
    s_movk_i32 s27, 1928
    s_movk_i32 s28, 1152
    v_add_u32 v6, 0, v0
    v_mul_u32_u24 v7, s27, v6
    v_lshrrev_b32 v7, 16, v7
    v_mul_u32_u24 v8, 34, v7
    v_sub_u32 v6, v6, v8
    v_lshlrev_b32 v7, 7, v7
    v_mad_u32_u24 v6, v6, s28, v7
    v_add_u32 v16, s26, v6
    buffer_load_dword v15, v16, s[16:19], 0 offen
    v_add_u32 v6, 64, v0
    v_mul_u32_u24 v7, s27, v6
    v_lshrrev_b32 v7, 16, v7
    v_mul_u32_u24 v8, 34, v7
    v_sub_u32 v6, v6, v8
    v_lshlrev_b32 v7, 7, v7
    v_mad_u32_u24 v6, v6, s28, v7
    v_add_u32 v17, s26, v6
    v_add_u32 v6, 128, v0
    v_mul_u32_u24 v7, s27, v6
    v_lshrrev_b32 v7, 16, v7
    v_mul_u32_u24 v8, 34, v7
    v_sub_u32 v6, v6, v8
    v_lshlrev_b32 v7, 7, v7
    v_mad_u32_u24 v6, v6, s28, v7
    v_add_u32 v18, s26, v6
    v_add_u32 v6, 192, v0
    v_mul_u32_u24 v7, s27, v6
    v_lshrrev_b32 v7, 16, v7
    v_mul_u32_u24 v8, 34, v7
    v_sub_u32 v6, v6, v8
    v_lshlrev_b32 v7, 7, v7
    v_mad_u32_u24 v6, v6, s28, v7
    v_add_u32 v19, s26, v6
    v_add_u32 v6, 256, v0
    v_mul_u32_u24 v7, s27, v6
    v_lshrrev_b32 v7, 16, v7
    v_mul_u32_u24 v8, 34, v7
    v_sub_u32 v6, v6, v8
    v_lshlrev_b32 v7, 7, v7
    v_mad_u32_u24 v6, v6, s28, v7
    v_add_u32 v20, s26, v6
    s_waitcnt lgkmcnt(0)
L_nn_29:
    s_barrier
    s_and_b32 s23, s20, 3
    s_lshr_b32 s24, s20, 2
    v_and_b32 v1, 31, v0
    v_lshrrev_b32 v2, 5, v0
    s_mov_b32 s6, 0
    s_mov_b32 s7, 0x00020000
    s_mov_b32 s4, s12
    s_mov_b32 s5, s13
    s_mov_b32 s6, 20733952
    s_cmp_eq_u32 s43, 0
    s_cbranch_scc1 L_nw_33
    s_mul_i32 s29, s20, 2304
    s_add_u32 s29, s29, 106752
    s_movk_i32 s26, 2731
    s_movk_i32 s27, 21846
    s_mov_b32 s28, 129024
    v_add_u32 v3, 0, v0
    v_mul_u32_u24 v4, s26, v3
    v_lshrrev_b32 v4, 16, v4
    v_mul_u32_u24 v5, 24, v4
    v_sub_u32 v5, v3, v5
    v_mul_u32_u24 v6, s27, v5
    v_lshrrev_b32 v6, 16, v6
    v_mul_u32_u24 v6, 15, v6
    v_lshrrev_b32 v7, 2, v4
    v_add3_u32 v6, v6, v5, v7
    v_lshl_add_u32 v6, v4, 1, v6
    v_lshl_add_u32 v148, v6, 4, s29
    v_mul_lo_u32 v4, v4, s28
    v_lshl_add_u32 v151, v5, 4, v4
    v_add_u32 v3, 64, v0
    v_mul_u32_u24 v4, s26, v3
    v_lshrrev_b32 v4, 16, v4
    v_mul_u32_u24 v5, 24, v4
    v_sub_u32 v5, v3, v5
    v_mul_u32_u24 v6, s27, v5
    v_lshrrev_b32 v6, 16, v6
    v_mul_u32_u24 v6, 15, v6
    v_lshrrev_b32 v7, 2, v4
    v_add3_u32 v6, v6, v5, v7
    v_lshl_add_u32 v6, v4, 1, v6
    v_lshl_add_u32 v149, v6, 4, s29
    v_mul_lo_u32 v4, v4, s28
    v_lshl_add_u32 v152, v5, 4, v4
    v_add_u32 v3, 128, v0
    v_mul_u32_u24 v4, s26, v3
    v_lshrrev_b32 v4, 16, v4
    v_mul_u32_u24 v5, 24, v4
    v_sub_u32 v5, v3, v5
    v_mul_u32_u24 v6, s27, v5
    v_lshrrev_b32 v6, 16, v6
    v_mul_u32_u24 v6, 15, v6
    v_lshrrev_b32 v7, 2, v4
    v_add3_u32 v6, v6, v5, v7
    v_lshl_add_u32 v6, v4, 1, v6
    v_lshl_add_u32 v150, v6, 4, s29
    v_mul_lo_u32 v4, v4, s28
    v_lshl_add_u32 v153, v5, 4, v4
    s_lshr_b32 s27, s34, 3
    s_mul_i32 s27, s27, 18432
    s_and_b32 s26, s34, 7
    s_mul_i32 s26, s26, 384
    s_add_u32 s26, s26, s27
    s_and_b32 s27, s21, 248
    s_mul_i32 s27, s27, 129024
    s_add_u32 s26, s26, s27
    s_and_b32 s27, s20, 1
    s_mul_i32 s27, s27, 9216
    s_add_u32 s26, s26, s27
    s_lshr_b32 s27, s20, 1
    s_mul_i32 s27, s27, 3072
    s_add_u32 s26, s26, s27
    s_add_u32 s26, s26, 7348224
    s_waitcnt vmcnt(0)
    ds_read_b128 v[136:139], v148
    ds_read_b128 v[140:143], v149
    ds_read_b128 v[144:147], v150
    s_waitcnt lgkmcnt(2)
    buffer_store_dwordx4 v[136:139], v151, s[4:7], s26 offen sc1
    s_waitcnt lgkmcnt(1)
    buffer_store_dwordx4 v[140:143], v152, s[4:7], s26 offen sc1
    s_waitcnt lgkmcnt(0)
    buffer_store_dwordx4 v[144:147], v153, s[4:7], s26 offen sc1
    s_branch L_ns_32
L_nw_33:
    s_cmp_lg_u32 s20, 7
    s_cbranch_scc1 L_ns_32
    s_waitcnt vmcnt(1)
    v_mov_b32 v4, s40
    v_cmp_eq_u32 vcc, 0, v14
    s_nop 1
    v_cndmask_b32 v4, v14, v4, vcc
    v_mov_b32 v3, 160128
    s_mov_b64 exec, 1
    ds_write_b32 v3, v4
    s_mov_b64 exec, -1
    s_waitcnt lgkmcnt(0)
L_ns_32:
    s_barrier
    v_mov_b32 v159, 160128
    ds_read_b32 v159, v159
    s_lshr_b32 s26, s21, 1
    s_and_b32 s26, s26, 1
    s_lshl_b32 s26, s26, 3
    s_and_b32 s47, s21, 1
    s_lshl_b32 s27, s47, 3
    s_add_u32 s31, s26, s27
    s_xor_b32 s27, s47, 1
    s_lshl_b32 s27, s27, 5
    s_add_u32 s32, s26, s27
    v_lshrrev_b32 v3, 1, v1
    v_xor_b32 v3, v3, v2
    v_and_b32 v3, 7, v3
    v_lshlrev_b32 v3, 4, v3
    v_lshl_add_u32 v3, v1, 7, v3
    s_lshl_b32 s26, s23, 13
    s_add_u32 s26, s26, 2048
    v_add_u32 v124, s26, v3
    v_xor_b32 v125, 32, v124
    v_xor_b32 v126, 64, v124
    v_xor_b32 v127, 0x60, v124
    v_bfe_u32 v3, v0, 2, 2
    v_mul_u32_u24 v3, 192, v3
    v_mul_u32_u24 v4, 96, v2
    v_add3_u32 v3, v3, v4, 0
    v_add_u32 v3, 34816, v3
    v_bfe_u32 v4, v0, 4, 1
    v_and_b32 v5, 1, v0
    v_bfe_u32 v6, v0, 1, 1
    v_lshlrev_b32 v7, 4, v5
    v_lshl_add_u32 v7, v6, 3, v7
    s_movk_i32 s27, 9248
    v_mad_u32_u24 v7, v4, s27, v7
    v_add_u32 v7, v7, v3
    s_cmp_eq_u32 s24, 0
    s_cselect_b32 s28, 3088, 0
    s_add_u32 s28, s28, s31
    v_add_u32 v128, s28, v7
    v_add_u32 v129, 3088, v128
    v_mad_u32_u24 v7, v5, s27, v3
    v_mul_u32_u24 v4, 768, v4
    v_add3_u32 v7, v7, v4, s32
    v_mov_b32 v5, 0x30000
    v_cmp_eq_u32 vcc, 0, v6
    s_nop 1
    v_cndmask_b32 v133, v5, v7, vcc
    v_mul_u32_u24 v6, 3088, v6
    v_add_u32 v6, 3088, v6
    v_add_u32 v7, v7, v6
    s_mov_b32 s50, 0xffccffcc
    s_mov_b32 s51, 0xff33ff33
    s_cmp_eq_u32 s47, 1
    s_cselect_b32 s50, s50, s51
    s_mov_b32 s51, s50
    s_cmp_eq_u32 s24, 1
    s_cselect_b64 vcc, -1, 0
    v_cndmask_b32 v129, v129, v7, vcc
    s_and_b32 s28, s21, 248
    s_lshl_b32 s28, s28, 9
    s_and_b32 s26, s20, 1
    s_lshl_b32 s27, s26, 8
    s_add_u32 s28, s28, s27
    s_lshl_b32 s27, s34, 2
    s_add_u32 s28, s28, s27
    s_add_u32 s28, s28, 12288
    v_mov_b32 v6, 268435456
    v_lshlrev_b32 v7, 9, v0
    v_cmp_gt_u32 vcc, 8, v0
    s_nop 1
    v_cndmask_b32 v5, v6, v7, vcc
    s_lshl_b32 s26, s26, 2
    s_add_u32 s26, s26, 160132
    v_mov_b32 v6, s26
    v_mov_b32 v7, 1
    s_cmp_eq_u32 s43, 0
    s_cbranch_scc1 L_f2_34
    s_waitcnt vmcnt(0)
    s_mov_b64 exec, 1
    ds_add_rtn_u32 v7, v6, v7
    s_mov_b64 exec, -1
    s_waitcnt lgkmcnt(0)
    v_readfirstlane_b32 s26, v7
    s_cmp_lg_u32 s26, 2
    s_cbranch_scc1 L_f2_34
    buffer_store_dword v159, v5, s[4:7], s28 offen sc1
L_f2_34:
    s_setprio 0
    s_cmp_lg_u32 s24, 0
    s_cbranch_scc1 L_f3_kernel_role1
    s_waitcnt lgkmcnt(0)
    s_barrier
    ds_read_b64_tr_b16 v[100:101], v128 offset:0
    ds_read_b64_tr_b16 v[102:103], v128 offset:48
    ds_read_b128 v[84:87], v124 offset:0
    ds_read_b128 v[88:91], v124 offset:4096
    ds_read_b64_tr_b16 v[104:105], v129 offset:0
    ds_read_b64_tr_b16 v[106:107], v129 offset:48
    s_waitcnt lgkmcnt(3)
    v_mfma_f32_32x32x16_bf16 v[16:31], v[100:103], v[84:87], 0
    ds_read_b64_tr_b16 v[108:109], v128 offset:768
    ds_read_b64_tr_b16 v[110:111], v128 offset:816
    s_waitcnt lgkmcnt(4)
    v_mfma_f32_32x32x16_bf16 v[32:47], v[100:103], v[88:91], 0
    ds_read_b128 v[92:95], v125 offset:0
    ds_read_b128 v[96:99], v125 offset:4096
    s_waitcnt lgkmcnt(4)
    v_mfma_f32_32x32x16_bf16 v[48:63], v[104:107], v[84:87], 0
    ds_read_b64_tr_b16 v[112:113], v129 offset:768
    ds_read_b64_tr_b16 v[114:115], v129 offset:816
    v_mfma_f32_32x32x16_bf16 v[64:79], v[104:107], v[88:91], 0
    s_waitcnt lgkmcnt(3)
    v_mfma_f32_32x32x16_bf16 v[16:31], v[108:111], v[92:95], v[16:31]
    ds_read_b64_tr_b16 v[100:101], v128 offset:1536
    ds_read_b64_tr_b16 v[102:103], v128 offset:1584
    s_waitcnt lgkmcnt(4)
    v_mfma_f32_32x32x16_bf16 v[32:47], v[108:111], v[96:99], v[32:47]
    ds_read_b128 v[84:87], v126 offset:0
    ds_read_b128 v[88:91], v126 offset:4096
    s_waitcnt lgkmcnt(4)
    v_mfma_f32_32x32x16_bf16 v[48:63], v[112:115], v[92:95], v[48:63]
    ds_read_b64_tr_b16 v[104:105], v129 offset:1536
    ds_read_b64_tr_b16 v[106:107], v129 offset:1584
    v_mfma_f32_32x32x16_bf16 v[64:79], v[112:115], v[96:99], v[64:79]
    s_waitcnt lgkmcnt(3)
    v_mfma_f32_32x32x16_bf16 v[16:31], v[100:103], v[84:87], v[16:31]
    ds_read_b64_tr_b16 v[108:109], v128 offset:2304
    ds_read_b64_tr_b16 v[110:111], v128 offset:2352
    ds_read_b128 v[92:95], v127 offset:0
    s_waitcnt lgkmcnt(5)
    v_mfma_f32_32x32x16_bf16 v[32:47], v[100:103], v[88:91], v[32:47]
    ds_read_b128 v[96:99], v127 offset:4096
    ds_read_b64_tr_b16 v[112:113], v129 offset:2304
    ds_read_b64_tr_b16 v[114:115], v129 offset:2352
    s_waitcnt lgkmcnt(6)
    v_mfma_f32_32x32x16_bf16 v[48:63], v[104:107], v[84:87], v[48:63]
    v_mfma_f32_32x32x16_bf16 v[64:79], v[104:107], v[88:91], v[64:79]
    s_mov_b32 s45, 53376
    s_mov_b32 s46, 53376
    v_add_u32 v124, s46, v124
    v_add_u32 v125, s46, v125
    v_add_u32 v126, s46, v126
    v_add_u32 v127, s46, v127
    v_add_u32 v128, s46, v128
    v_add_u32 v129, s46, v129
    v_and_b32 v1, 31, v0
    v_lshrrev_b32 v2, 5, v0
    v_lshlrev_b32 v3, 2, v2
    v_xor_b32 v3, v3, v1
    v_lshlrev_b32 v3, 4, v3
    v_lshl_add_u32 v142, v2, 9, v3
    v_lshlrev_b32 v4, 2, v1
    s_lshl_b32 s26, s22, 3
    s_lshl_b32 s27, s23, 1
    s_add_u32 s32, s27, s24
    s_lshl_b32 s31, s32, 10
    s_add_u32 s31, s31, 90624
    v_add_u32 v149, s31, v142
    s_lshl_b32 s31, s32, 7
    s_add_u32 s31, s31, 98816
    v_add_u32 v150, s31, v4
    s_add_u32 s27, s32, s26
    s_lshl_b32 s29, s21, 10
    s_add_u32 s29, s29, 4096
    s_lshl_b32 s30, s21, 7
    s_mul_i32 s27, s27, 36864
    s_add_u32 s27, s27, 17047552
    s_add_u32 s36, s27, s29
    s_add_u32 s39, s27, s30
    s_add_u32 s26, s26, s20
    s_mul_i32 s27, s26, 36864
    s_add_u32 s27, s27, 14688256
    s_add_u32 s35, s27, s29
    s_add_u32 s38, s27, s30
    s_mul_i32 s37, s21, 155648
    s_mul_i32 s27, s22, 19456
    s_add_u32 s37, s37, s27
    s_add_u32 s37, s37, 2367488
    s_lshl_b32 s26, s24, 12
    v_add_u32 v136, s26, v142
    v_add_u32 v143, 18432, v4
    s_lshl_b32 s26, s24, 9
    v_add_u32 v137, s26, v143
    v_lshrrev_b32 v6, 2, v0
    v_and_b32 v6, 3, v6
    v_lshl_add_u32 v6, v2, 2, v6
    v_and_b32 v7, 1, v0
    v_lshlrev_b32 v8, 2, v7
    v_xor_b32 v8, v8, v6
    v_lshlrev_b32 v8, 4, v8
    v_lshl_add_u32 v8, v7, 9, v8
    v_lshrrev_b32 v7, 1, v0
    v_and_b32 v7, 1, v7
    v_lshl_add_u32 v8, v7, 3, v8
    v_lshlrev_b32 v9, 3, v6
    v_add_u32 v9, 1024, v9
    v_and_b32 v7, 16, v0
    v_cmp_eq_u32 vcc, 0, v7
    s_nop 1
    v_cndmask_b32 v8, v9, v8, vcc
    v_mov_b32 v9, 64
    v_mov_b32 v10, 128
    v_cndmask_b32 v9, v9, v10, vcc
    s_mul_i32 s26, s24, 5120
    s_add_u32 s26, s26, 8192
    v_add_u32 v138, s26, v8
    v_add_u32 v139, v138, v9
    v_add_u32 v140, v139, v9
    v_add_u32 v141, v140, v9
    v_and_b32 v9, 3, v0
    v_cmp_ne_u32 vcc, 0, v9
    s_nop 1
    v_cndmask_b32 v9, 0, v7, vcc
    v_mov_b32 v10, 0x30000
    v_cmp_ne_u32 vcc, 0, v9
    s_nop 1
    v_cndmask_b32 v138, v138, v10, vcc
    v_cndmask_b32 v139, v139, v10, vcc
    v_cndmask_b32 v140, v140, v10, vcc
    v_cndmask_b32 v141, v141, v10, vcc
    v_lshlrev_b32 v146, 4, v0
    s_mul_i32 s26, s20, 3072
    s_add_u32 s26, s26, 82944
    v_add_u32 v144, s26, v146
    s_xor_b32 s28, s20, 4
    s_mul_i32 s26, s28, 3072
    s_add_u32 s26, s26, 82944
    v_add_u32 v145, s26, v146
    v_lshlrev_b32 v11, 2, v1
    v_lshl_add_u32 v147, v2, 28, v11
    v_and_b32 v6, 7, v0
    v_lshlrev_b32 v6, 2, v6
    v_add_u32 v148, 155648, v6
    s_mul_i32 s26, s20, 3584
    s_add_u32 s26, s26, 58368
    v_and_b32 v6, 15, v0
    v_lshrrev_b32 v7, 4, v0
    v_and_b32 v8, 1, v7
    v_lshlrev_b32 v9, 1, v6
    v_lshlrev_b32 v10, 2, v8
    v_xor_b32 v10, v10, v9
    v_lshlrev_b32 v10, 4, v10
    v_lshl_add_u32 v10, v8, 9, v10
    v_add_u32 v152, s26, v10
    v_lshl_add_u32 v153, v9, 2, s26
    v_lshrrev_b32 v10, 1, v7
    v_lshlrev_b32 v11, 4, v9
    v_mov_b32 v12, 268435456
    v_cmp_eq_u32 vcc, 0, v7
    v_lshlrev_b32 v13, 3, v6
    s_nop 0
    v_cndmask_b32 v157, v12, v13, vcc
    v_lshl_add_u32 v11, v10, 9, v11
    v_lshl_add_u32 v156, v8, 4, v11
    v_lshrrev_b32 v10, 2, v6
    v_lshlrev_b32 v10, 1, v10
    v_lshl_add_u32 v10, v7, 3, v10
    v_lshl_add_u32 v155, v10, 3, s26
    v_lshrrev_b32 v11, 1, v0
    v_and_b32 v11, 1, v11
    v_lshlrev_b32 v12, 2, v11
    v_xor_b32 v12, v12, v10
    v_lshlrev_b32 v12, 4, v12
    v_lshl_add_u32 v12, v11, 9, v12
    v_and_b32 v11, 1, v0
    v_lshl_add_u32 v12, v11, 3, v12
    v_add_u32 v154, s26, v12
    v_lshlrev_b32 v7, 2, v7
    v_sub_u32 v6, v6, v7
    s_add_u32 s27, s22, s20
    s_cmp_eq_u32 s27, 0
    s_cselect_b32 s27, -100, -9
    v_mov_b32 v7, 0xff800000
    v_add_u32 v8, 0, v6
    v_cmp_ge_i32 vcc, s27, v8
    s_nop 1
    v_cndmask_b32 v160, v7, 0, vcc
    v_cmp_gt_u32 vcc, 8, v8
    s_nop 1
    v_cndmask_b32 v164, v7, 0, vcc
    v_add_u32 v8, -1, v6
    v_cmp_ge_i32 vcc, s27, v8
    s_nop 1
    v_cndmask_b32 v161, v7, 0, vcc
    v_cmp_gt_u32 vcc, 8, v8
    s_nop 1
    v_cndmask_b32 v165, v7, 0, vcc
    v_add_u32 v8, -2, v6
    v_cmp_ge_i32 vcc, s27, v8
    s_nop 1
    v_cndmask_b32 v162, v7, 0, vcc
    v_cmp_gt_u32 vcc, 8, v8
    s_nop 1
    v_cndmask_b32 v166, v7, 0, vcc
    v_add_u32 v8, -3, v6
    v_cmp_ge_i32 vcc, s27, v8
    s_nop 1
    v_cndmask_b32 v163, v7, 0, vcc
    v_cmp_gt_u32 vcc, 8, v8
    s_nop 1
    v_cndmask_b32 v167, v7, 0, vcc
    v_lshlrev_b32 v4, 2, v1
    v_lshlrev_b32 v5, 3, v1
    v_cmp_eq_u32 vcc, 0, v2
    s_lshl_b32 s26, s23, 1
    s_add_u32 s26, s26, 0
    s_mul_i32 s27, s26, 3584
    s_add_u32 s27, s27, 61952
    s_lshl_b32 s28, s26, 7
    s_mul_i32 s29, s26, 1280
    s_add_u32 s30, s27, 2304
    s_add_u32 s33, s28, 18432
    v_mov_b32 v6, s30
    v_mov_b32 v7, s33
    v_cndmask_b32 v6, v7, v6, vcc
    v_add_u32 v8, v6, v4
    s_add_u32 s30, s27, 2048
    s_add_u32 s33, s29, 9216
    v_mov_b32 v6, s30
    v_mov_b32 v7, s33
    v_cndmask_b32 v6, v7, v6, vcc
    v_add_u32 v10, v6, v5
    s_add_u32 s30, s27, 3456
    s_add_u32 s33, s28, 98816
    v_mov_b32 v6, s30
    v_mov_b32 v7, s33
    v_cndmask_b32 v6, v7, v6, vcc
    v_add_u32 v12, v6, v4
    s_lshl_b32 s26, s23, 1
    s_add_u32 s26, s26, 1
    s_mul_i32 s27, s26, 3584
    s_add_u32 s27, s27, 61952
    s_lshl_b32 s28, s26, 7
    s_mul_i32 s29, s26, 1280
    s_add_u32 s30, s27, 2304
    s_add_u32 s33, s28, 18432
    v_mov_b32 v6, s30
    v_mov_b32 v7, s33
    v_cndmask_b32 v6, v7, v6, vcc
    v_add_u32 v9, v6, v4
    s_add_u32 s30, s27, 2048
    s_add_u32 s33, s29, 9216
    v_mov_b32 v6, s30
    v_mov_b32 v7, s33
    v_cndmask_b32 v6, v7, v6, vcc
    v_add_u32 v11, v6, v5
    s_add_u32 s30, s27, 3456
    s_add_u32 s33, s28, 98816
    v_mov_b32 v6, s30
    v_mov_b32 v7, s33
    v_cndmask_b32 v6, v7, v6, vcc
    v_add_u32 v13, v6, v4
    s_mov_b32 s44, 1
L_f3_kernel_gloop0:
    s_waitcnt lgkmcnt(0)
    s_barrier
    v_mfma_f32_32x32x16_bf16 v[16:31], v[108:111], v[92:95], v[16:31]
    ds_read_b64_tr_b16 v[100:101], v128 offset:0
    ds_read_b64_tr_b16 v[102:103], v128 offset:48
    v_mfma_f32_32x32x16_bf16 v[32:47], v[108:111], v[96:99], v[32:47]
    ds_read_b128 v[84:87], v124 offset:0
    ds_read_b128 v[88:91], v124 offset:4096
    v_mfma_f32_32x32x16_bf16 v[48:63], v[112:115], v[92:95], v[48:63]
    ds_read_b64_tr_b16 v[104:105], v129 offset:0
    ds_read_b64_tr_b16 v[106:107], v129 offset:48
    v_mfma_f32_32x32x16_bf16 v[64:79], v[112:115], v[96:99], v[64:79]
    s_waitcnt lgkmcnt(3)
    v_mfma_f32_32x32x16_bf16 v[16:31], v[100:103], v[84:87], v[16:31]
    ds_read_b64_tr_b16 v[108:109], v128 offset:768
    ds_read_b64_tr_b16 v[110:111], v128 offset:816
    s_waitcnt lgkmcnt(4)
    v_mfma_f32_32x32x16_bf16 v[32:47], v[100:103], v[88:91], v[32:47]
    ds_read_b128 v[92:95], v125 offset:0
    ds_read_b128 v[96:99], v125 offset:4096
    s_waitcnt lgkmcnt(4)
    v_mfma_f32_32x32x16_bf16 v[48:63], v[104:107], v[84:87], v[48:63]
    ds_read_b64_tr_b16 v[112:113], v129 offset:768
    ds_read_b64_tr_b16 v[114:115], v129 offset:816
    v_mfma_f32_32x32x16_bf16 v[64:79], v[104:107], v[88:91], v[64:79]
    s_waitcnt lgkmcnt(3)
    v_mfma_f32_32x32x16_bf16 v[16:31], v[108:111], v[92:95], v[16:31]
    ds_read_b64_tr_b16 v[100:101], v128 offset:1536
    ds_read_b64_tr_b16 v[102:103], v128 offset:1584
    s_waitcnt lgkmcnt(4)
    v_mfma_f32_32x32x16_bf16 v[32:47], v[108:111], v[96:99], v[32:47]
    ds_read_b128 v[84:87], v126 offset:0
    ds_read_b128 v[88:91], v126 offset:4096
    s_waitcnt lgkmcnt(4)
    v_mfma_f32_32x32x16_bf16 v[48:63], v[112:115], v[92:95], v[48:63]
    ds_read_b64_tr_b16 v[104:105], v129 offset:1536
    ds_read_b64_tr_b16 v[106:107], v129 offset:1584
    v_mfma_f32_32x32x16_bf16 v[64:79], v[112:115], v[96:99], v[64:79]
    s_waitcnt lgkmcnt(3)
    v_mfma_f32_32x32x16_bf16 v[16:31], v[100:103], v[84:87], v[16:31]
    ds_read_b64_tr_b16 v[108:109], v128 offset:2304
    ds_read_b64_tr_b16 v[110:111], v128 offset:2352
    ds_read_b128 v[92:95], v127 offset:0
    s_waitcnt lgkmcnt(5)
    v_mfma_f32_32x32x16_bf16 v[32:47], v[100:103], v[88:91], v[32:47]
    ds_read_b128 v[96:99], v127 offset:4096
    ds_read_b64_tr_b16 v[112:113], v129 offset:2304
    ds_read_b64_tr_b16 v[114:115], v129 offset:2352
    s_waitcnt lgkmcnt(6)
    v_mfma_f32_32x32x16_bf16 v[48:63], v[104:107], v[84:87], v[48:63]
    v_mfma_f32_32x32x16_bf16 v[64:79], v[104:107], v[88:91], v[64:79]
    s_add_u32 s45, s45, 53376
    s_cmp_eq_u32 s45, 160128
    s_mov_b32 s46, 53376
    s_cselect_b32 s46, 4294860544, s46
    s_cselect_b32 s45, 0, s45
    v_add_u32 v124, s46, v124
    v_add_u32 v125, s46, v125
    v_add_u32 v126, s46, v126
    v_add_u32 v127, s46, v127
    v_add_u32 v128, s46, v128
    v_add_u32 v129, s46, v129
    s_add_u32 s44, s44, 1
    s_cmp_lt_u32 s44, 9
    s_cbranch_scc1 L_f3_kernel_gloop0
    s_waitcnt lgkmcnt(0)
    v_mfma_f32_32x32x16_bf16 v[16:31], v[108:111], v[92:95], v[16:31]
    v_mfma_f32_32x32x16_bf16 v[32:47], v[108:111], v[96:99], v[32:47]
    v_mfma_f32_32x32x16_bf16 v[48:63], v[112:115], v[92:95], v[48:63]
    v_mfma_f32_32x32x16_bf16 v[64:79], v[112:115], v[96:99], v[64:79]
    s_lshl_b32 s26, s23, 1
    s_mul_i32 s27, s26, 3584
    s_add_u32 s27, s27, 61952
    v_add_u32 v1, s27, v142
    s_lshl_b32 s27, s26, 10
    v_add_u32 v2, s27, v142
    s_mul_i32 s27, s26, 1280
    s_add_u32 s27, s27, 8192
    v_add_u32 v3, s27, v142
    v_cvt_pk_bf16_f32 v24, v24, v25
    v_cvt_pk_bf16_f32 v25, v26, v27
    v_cvt_pk_bf16_f32 v26, v28, v29
    v_cvt_pk_bf16_f32 v27, v30, v31
    ds_write_b128 v2, v[24:27] offset:0
    v_cvt_pk_bf16_f32 v16, v16, v17
    v_cvt_pk_bf16_f32 v17, v18, v19
    v_cvt_pk_bf16_f32 v18, v20, v21
    v_cvt_pk_bf16_f32 v19, v22, v23
    ds_write_b128 v1, v[16:19] offset:0
    v_cvt_pk_bf16_f32 v40, v40, v41
    v_cvt_pk_bf16_f32 v41, v42, v43
    v_cvt_pk_bf16_f32 v42, v44, v45
    v_cvt_pk_bf16_f32 v43, v46, v47
    ds_write_b128 v2, v[40:43] offset:1024
    v_cvt_pk_bf16_f32 v32, v32, v33
    v_cvt_pk_bf16_f32 v33, v34, v35
    v_cvt_pk_bf16_f32 v34, v36, v37
    v_cvt_pk_bf16_f32 v35, v38, v39
    ds_write_b128 v1, v[32:35] offset:3584
    v_cvt_pk_bf16_f32 v56, v56, v57
    v_cvt_pk_bf16_f32 v57, v58, v59
    v_cvt_pk_bf16_f32 v58, v60, v61
    v_cvt_pk_bf16_f32 v59, v62, v63
    ds_write_b128 v3, v[56:59] offset:0
    v_cvt_pk_bf16_f32 v48, v48, v49
    v_cvt_pk_bf16_f32 v49, v50, v51
    v_cvt_pk_bf16_f32 v50, v52, v53
    v_cvt_pk_bf16_f32 v51, v54, v55
    ds_write_b128 v1, v[48:51] offset:1024
    v_cvt_pk_bf16_f32 v72, v72, v73
    v_cvt_pk_bf16_f32 v73, v74, v75
    v_cvt_pk_bf16_f32 v74, v76, v77
    v_cvt_pk_bf16_f32 v75, v78, v79
    ds_write_b128 v3, v[72:75] offset:1280
    v_cvt_pk_bf16_f32 v64, v64, v65
    v_cvt_pk_bf16_f32 v65, v66, v67
    v_cvt_pk_bf16_f32 v66, v68, v69
    v_cvt_pk_bf16_f32 v67, v70, v71
    ds_write_b128 v1, v[64:67] offset:4608
    s_waitcnt lgkmcnt(0)
    s_barrier
    s_branch L_f3_kernel_post
L_f3_kernel_role1:
    s_lshr_b32 s26, s21, 1
    s_and_b32 s26, s26, 1
    s_lshl_b32 s26, s26, 3
    s_lshl_b32 s27, s47, 3
    s_add_u32 s31, s26, s27
    s_xor_b32 s27, s47, 1
    s_lshl_b32 s27, s27, 5
    s_add_u32 s32, s26, s27
    v_and_b32 v3, 15, v0
    v_lshrrev_b32 v4, 4, v0
    v_lshrrev_b32 v5, 1, v3
    v_xor_b32 v5, v5, v4
    v_and_b32 v5, 7, v5
    v_lshlrev_b32 v5, 4, v5
    v_lshl_add_u32 v5, v3, 7, v5
    s_lshl_b32 s26, s23, 13
    s_add_u32 s26, s26, 2048
    v_add_u32 v124, s26, v5
    v_xor_b32 v125, 64, v124
    v_bfe_u32 v5, v0, 2, 2
    v_mul_u32_u24 v5, 192, v5
    v_lshrrev_b32 v6, 1, v4
    v_mul_u32_u24 v6, 768, v6
    v_and_b32 v7, 1, v4
    v_mul_u32_u24 v7, 96, v7
    v_add3_u32 v5, v5, v6, v7
    v_add_u32 v5, 34816, v5
    v_and_b32 v6, 3, v0
    v_lshl_add_u32 v7, v6, 3, v5
    v_add_u32 v128, s31, v7
    v_and_b32 v7, 1, v6
    s_movk_i32 s27, 9248
    v_mad_u32_u24 v7, v7, s27, v5
    v_add_u32 v7, s32, v7
    v_lshrrev_b32 v6, 1, v6
    v_mov_b32 v5, 0x30000
    v_cmp_eq_u32 vcc, 0, v6
    s_nop 1
    v_cndmask_b32 v133, v5, v7, vcc
    v_mul_u32_u24 v6, 3088, v6
    v_add_u32 v6, 3088, v6
    v_add_u32 v129, v7, v6
    s_mov_b64 vcc, s[50:51]
    s_waitcnt lgkmcnt(0)
    s_barrier
    ds_read_b64_tr_b16 v[100:101], v128 offset:0
    ds_read_b64_tr_b16 v[102:103], v128 offset:48
    ds_read_b128 v[84:87], v124 offset:0
    ds_read_b128 v[88:91], v124 offset:2048
    ds_read_b128 v[92:95], v124 offset:4096
    ds_read_b128 v[96:99], v124 offset:6144
    ds_read_b64_tr_b16 v[104:105], v128 offset:9248
    ds_read_b64_tr_b16 v[106:107], v128 offset:9296
    ds_read_b64_tr_b16 v[108:109], v129 offset:0
    ds_read_b64_tr_b16 v[110:111], v129 offset:48
    ds_read_b64_tr_b16 v[80:81], v133 offset:0
    ds_read_b64_tr_b16 v[82:83], v133 offset:48
    s_waitcnt lgkmcnt(9)
    v_mfma_f32_16x16x32_bf16 v[16:19], v[100:103], v[84:87], 0
    ds_read_b64_tr_b16 v[112:113], v128 offset:1536
    ds_read_b64_tr_b16 v[114:115], v128 offset:1584
    s_waitcnt lgkmcnt(10)
    v_mfma_f32_16x16x32_bf16 v[20:23], v[100:103], v[88:91], 0
    ds_read_b128 v[64:67], v125 offset:0
    s_waitcnt lgkmcnt(10)
    v_mfma_f32_16x16x32_bf16 v[24:27], v[100:103], v[92:95], 0
    ds_read_b128 v[68:71], v125 offset:2048
    s_waitcnt lgkmcnt(10)
    v_mfma_f32_16x16x32_bf16 v[28:31], v[100:103], v[96:99], 0
    ds_read_b128 v[72:75], v125 offset:4096
    s_waitcnt lgkmcnt(5)
    v_cndmask_b32_dpp v108, v80, v108, vcc quad_perm:[2,3,0,1] row_mask:0xf bank_mask:0xf
    v_cndmask_b32_dpp v109, v81, v109, vcc quad_perm:[2,3,0,1] row_mask:0xf bank_mask:0xf
    v_cndmask_b32_dpp v110, v82, v110, vcc quad_perm:[2,3,0,1] row_mask:0xf bank_mask:0xf
    v_cndmask_b32_dpp v111, v83, v111, vcc quad_perm:[2,3,0,1] row_mask:0xf bank_mask:0xf
    ds_read_b128 v[76:79], v125 offset:6144
    v_mfma_f32_16x16x32_bf16 v[32:35], v[104:107], v[84:87], 0
    ds_read_b64_tr_b16 v[116:117], v128 offset:10784
    ds_read_b64_tr_b16 v[118:119], v128 offset:10832
    v_mfma_f32_16x16x32_bf16 v[36:39], v[104:107], v[88:91], 0
    ds_read_b64_tr_b16 v[120:121], v129 offset:1536
    ds_read_b64_tr_b16 v[122:123], v129 offset:1584
    v_mfma_f32_16x16x32_bf16 v[40:43], v[104:107], v[92:95], 0
    ds_read_b64_tr_b16 v[80:81], v133 offset:1536
    ds_read_b64_tr_b16 v[82:83], v133 offset:1584
    v_mfma_f32_16x16x32_bf16 v[44:47], v[104:107], v[96:99], 0
    v_mfma_f32_16x16x32_bf16 v[48:51], v[108:111], v[84:87], 0
    v_mfma_f32_16x16x32_bf16 v[52:55], v[108:111], v[88:91], 0
    v_mfma_f32_16x16x32_bf16 v[56:59], v[108:111], v[92:95], 0
    v_mfma_f32_16x16x32_bf16 v[60:63], v[108:111], v[96:99], 0
    s_mov_b32 s45, 53376
    s_mov_b32 s46, 53376
    v_add_u32 v124, s46, v124
    v_add_u32 v125, s46, v125
    v_add_u32 v128, s46, v128
    v_add_u32 v129, s46, v129
    v_add_u32 v133, s46, v133
    v_and_b32 v1, 31, v0
    v_lshrrev_b32 v2, 5, v0
    v_lshlrev_b32 v3, 2, v2
    v_xor_b32 v3, v3, v1
    v_lshlrev_b32 v3, 4, v3
    v_lshl_add_u32 v142, v2, 9, v3
    v_lshlrev_b32 v4, 2, v1
    s_lshl_b32 s26, s22, 3
    s_lshl_b32 s27, s23, 1
    s_add_u32 s32, s27, s24
    s_lshl_b32 s31, s32, 10
    s_add_u32 s31, s31, 90624
    v_add_u32 v149, s31, v142
    s_lshl_b32 s31, s32, 7
    s_add_u32 s31, s31, 98816
    v_add_u32 v150, s31, v4
    s_add_u32 s27, s32, s26
    s_lshl_b32 s29, s21, 10
    s_add_u32 s29, s29, 4096
    s_lshl_b32 s30, s21, 7
    s_mul_i32 s27, s27, 36864
    s_add_u32 s27, s27, 17047552
    s_add_u32 s36, s27, s29
    s_add_u32 s39, s27, s30
    s_add_u32 s26, s26, s20
    s_mul_i32 s27, s26, 36864
    s_add_u32 s27, s27, 14688256
    s_add_u32 s35, s27, s29
    s_add_u32 s38, s27, s30
    s_mul_i32 s37, s21, 155648
    s_mul_i32 s27, s22, 19456
    s_add_u32 s37, s37, s27
    s_add_u32 s37, s37, 2367488
    s_lshl_b32 s26, s24, 12
    v_add_u32 v136, s26, v142
    v_add_u32 v143, 18432, v4
    s_lshl_b32 s26, s24, 9
    v_add_u32 v137, s26, v143
    v_lshrrev_b32 v6, 2, v0
    v_and_b32 v6, 3, v6
    v_lshl_add_u32 v6, v2, 2, v6
    v_and_b32 v7, 1, v0
    v_lshlrev_b32 v8, 2, v7
    v_xor_b32 v8, v8, v6
    v_lshlrev_b32 v8, 4, v8
    v_lshl_add_u32 v8, v7, 9, v8
    v_lshrrev_b32 v7, 1, v0
    v_and_b32 v7, 1, v7
    v_lshl_add_u32 v8, v7, 3, v8
    v_lshlrev_b32 v9, 3, v6
    v_add_u32 v9, 1024, v9
    v_and_b32 v7, 16, v0
    v_cmp_eq_u32 vcc, 0, v7
    s_nop 1
    v_cndmask_b32 v8, v9, v8, vcc
    v_mov_b32 v9, 64
    v_mov_b32 v10, 128
    v_cndmask_b32 v9, v9, v10, vcc
    s_mul_i32 s26, s24, 5120
    s_add_u32 s26, s26, 8192
    v_add_u32 v138, s26, v8
    v_add_u32 v139, v138, v9
    v_add_u32 v140, v139, v9
    v_add_u32 v141, v140, v9
    v_and_b32 v9, 3, v0
    v_cmp_ne_u32 vcc, 0, v9
    s_nop 1
    v_cndmask_b32 v9, 0, v7, vcc
    v_mov_b32 v10, 0x30000
    v_cmp_ne_u32 vcc, 0, v9
    s_nop 1
    v_cndmask_b32 v138, v138, v10, vcc
    v_cndmask_b32 v139, v139, v10, vcc
    v_cndmask_b32 v140, v140, v10, vcc
    v_cndmask_b32 v141, v141, v10, vcc
    v_lshlrev_b32 v146, 4, v0
    s_mul_i32 s26, s20, 3072
    s_add_u32 s26, s26, 82944
    v_add_u32 v144, s26, v146
    s_xor_b32 s28, s20, 4
    s_mul_i32 s26, s28, 3072
    s_add_u32 s26, s26, 82944
    v_add_u32 v145, s26, v146
    v_lshlrev_b32 v11, 2, v1
    v_lshl_add_u32 v147, v2, 28, v11
    v_and_b32 v6, 7, v0
    v_lshlrev_b32 v6, 2, v6
    v_add_u32 v148, 155648, v6
    s_mul_i32 s26, s20, 3584
    s_add_u32 s26, s26, 58368
    v_and_b32 v6, 15, v0
    v_lshrrev_b32 v7, 4, v0
    v_and_b32 v8, 1, v7
    v_lshlrev_b32 v9, 1, v6
    v_lshlrev_b32 v10, 2, v8
    v_xor_b32 v10, v10, v9
    v_lshlrev_b32 v10, 4, v10
    v_lshl_add_u32 v10, v8, 9, v10
    v_add_u32 v152, s26, v10
    v_lshl_add_u32 v153, v9, 2, s26
    v_lshrrev_b32 v10, 1, v7
    v_lshlrev_b32 v11, 4, v9
    v_mov_b32 v12, 268435456
    v_cmp_eq_u32 vcc, 0, v7
    v_lshlrev_b32 v13, 3, v6
    s_nop 0
    v_cndmask_b32 v157, v12, v13, vcc
    v_lshl_add_u32 v11, v10, 9, v11
    v_lshl_add_u32 v156, v8, 4, v11
    v_lshrrev_b32 v10, 2, v6
    v_lshlrev_b32 v10, 1, v10
    v_lshl_add_u32 v10, v7, 3, v10
    v_lshl_add_u32 v155, v10, 3, s26
    v_lshrrev_b32 v11, 1, v0
    v_and_b32 v11, 1, v11
    v_lshlrev_b32 v12, 2, v11
    v_xor_b32 v12, v12, v10
    v_lshlrev_b32 v12, 4, v12
    v_lshl_add_u32 v12, v11, 9, v12
    v_and_b32 v11, 1, v0
    v_lshl_add_u32 v12, v11, 3, v12
    v_add_u32 v154, s26, v12
    v_lshlrev_b32 v7, 2, v7
    v_sub_u32 v6, v6, v7
    s_add_u32 s27, s22, s20
    s_cmp_eq_u32 s27, 0
    s_cselect_b32 s27, -100, -9
    v_mov_b32 v7, 0xff800000
    v_add_u32 v8, 0, v6
    v_cmp_ge_i32 vcc, s27, v8
    s_nop 1
    v_cndmask_b32 v160, v7, 0, vcc
    v_cmp_gt_u32 vcc, 8, v8
    s_nop 1
    v_cndmask_b32 v164, v7, 0, vcc
    v_add_u32 v8, -1, v6
    v_cmp_ge_i32 vcc, s27, v8
    s_nop 1
    v_cndmask_b32 v161, v7, 0, vcc
    v_cmp_gt_u32 vcc, 8, v8
    s_nop 1
    v_cndmask_b32 v165, v7, 0, vcc
    v_add_u32 v8, -2, v6
    v_cmp_ge_i32 vcc, s27, v8
    s_nop 1
    v_cndmask_b32 v162, v7, 0, vcc
    v_cmp_gt_u32 vcc, 8, v8
    s_nop 1
    v_cndmask_b32 v166, v7, 0, vcc
    v_add_u32 v8, -3, v6
    v_cmp_ge_i32 vcc, s27, v8
    s_nop 1
    v_cndmask_b32 v163, v7, 0, vcc
    v_cmp_gt_u32 vcc, 8, v8
    s_nop 1
    v_cndmask_b32 v167, v7, 0, vcc
    v_and_b32 v4, 15, v0
    v_lshlrev_b32 v5, 3, v4
    v_lshlrev_b32 v4, 2, v4
    v_and_b32 v3, 16, v0
    s_lshl_b32 s26, s23, 1
    s_add_u32 s26, s26, 0
    s_mul_i32 s27, s26, 3584
    s_add_u32 s27, s27, 61952
    s_lshl_b32 s28, s26, 7
    s_mul_i32 s29, s26, 1280
    v_cmp_eq_u32 vcc, 0, v3
    s_add_u32 s30, s27, 2304
    s_add_u32 s33, s28, 18432
    v_mov_b32 v6, s30
    v_mov_b32 v7, s33
    v_cndmask_b32 v6, v7, v6, vcc
    v_add_u32 v8, v6, v4
    s_add_u32 s30, s27, 2048
    s_add_u32 s33, s29, 9216
    v_mov_b32 v6, s30
    v_mov_b32 v7, s33
    v_cndmask_b32 v6, v7, v6, vcc
    v_add_u32 v10, v6, v5
    s_add_u32 s30, s27, 3456
    s_add_u32 s33, s28, 98816
    v_mov_b32 v6, s30
    v_mov_b32 v7, s33
    v_cndmask_b32 v6, v7, v6, vcc
    v_add_u32 v12, v6, v4
    v_cmp_gt_u32 vcc, 32, v0
    s_nop 1
    v_cndmask_b32 v8, v10, v8, vcc
    s_lshl_b32 s26, s23, 1
    s_add_u32 s26, s26, 1
    s_mul_i32 s27, s26, 3584
    s_add_u32 s27, s27, 61952
    s_lshl_b32 s28, s26, 7
    s_mul_i32 s29, s26, 1280
    v_cmp_eq_u32 vcc, 0, v3
    s_add_u32 s30, s27, 2304
    s_add_u32 s33, s28, 18432
    v_mov_b32 v6, s30
    v_mov_b32 v7, s33
    v_cndmask_b32 v6, v7, v6, vcc
    v_add_u32 v9, v6, v4
    s_add_u32 s30, s27, 2048
    s_add_u32 s33, s29, 9216
    v_mov_b32 v6, s30
    v_mov_b32 v7, s33
    v_cndmask_b32 v6, v7, v6, vcc
    v_add_u32 v11, v6, v5
    s_add_u32 s30, s27, 3456
    s_add_u32 s33, s28, 98816
    v_mov_b32 v6, s30
    v_mov_b32 v7, s33
    v_cndmask_b32 v6, v7, v6, vcc
    v_add_u32 v13, v6, v4
    v_cmp_gt_u32 vcc, 32, v0
    s_nop 1
    v_cndmask_b32 v9, v11, v9, vcc
    s_mov_b64 vcc, s[50:51]
    s_mov_b32 s44, 1
L_f3_kernel_gloop1:
    s_waitcnt lgkmcnt(0)
    s_barrier
    v_mfma_f32_16x16x32_bf16 v[16:19], v[112:115], v[64:67], v[16:19]
    ds_read_b64_tr_b16 v[100:101], v128 offset:0
    ds_read_b64_tr_b16 v[102:103], v128 offset:48
    v_mfma_f32_16x16x32_bf16 v[20:23], v[112:115], v[68:71], v[20:23]
    ds_read_b128 v[84:87], v124 offset:0
    v_mfma_f32_16x16x32_bf16 v[24:27], v[112:115], v[72:75], v[24:27]
    ds_read_b128 v[88:91], v124 offset:2048
    v_mfma_f32_16x16x32_bf16 v[28:31], v[112:115], v[76:79], v[28:31]
    ds_read_b128 v[92:95], v124 offset:4096
    v_cndmask_b32_dpp v120, v80, v120, vcc quad_perm:[2,3,0,1] row_mask:0xf bank_mask:0xf
    v_cndmask_b32_dpp v121, v81, v121, vcc quad_perm:[2,3,0,1] row_mask:0xf bank_mask:0xf
    v_cndmask_b32_dpp v122, v82, v122, vcc quad_perm:[2,3,0,1] row_mask:0xf bank_mask:0xf
    v_cndmask_b32_dpp v123, v83, v123, vcc quad_perm:[2,3,0,1] row_mask:0xf bank_mask:0xf
    ds_read_b128 v[96:99], v124 offset:6144
    v_mfma_f32_16x16x32_bf16 v[32:35], v[116:119], v[64:67], v[32:35]
    ds_read_b64_tr_b16 v[104:105], v128 offset:9248
    ds_read_b64_tr_b16 v[106:107], v128 offset:9296
    v_mfma_f32_16x16x32_bf16 v[36:39], v[116:119], v[68:71], v[36:39]
    ds_read_b64_tr_b16 v[108:109], v129 offset:0
    ds_read_b64_tr_b16 v[110:111], v129 offset:48
    v_mfma_f32_16x16x32_bf16 v[40:43], v[116:119], v[72:75], v[40:43]
    ds_read_b64_tr_b16 v[80:81], v133 offset:0
    ds_read_b64_tr_b16 v[82:83], v133 offset:48
    v_mfma_f32_16x16x32_bf16 v[44:47], v[116:119], v[76:79], v[44:47]
    v_mfma_f32_16x16x32_bf16 v[48:51], v[120:123], v[64:67], v[48:51]
    v_mfma_f32_16x16x32_bf16 v[52:55], v[120:123], v[68:71], v[52:55]
    v_mfma_f32_16x16x32_bf16 v[56:59], v[120:123], v[72:75], v[56:59]
    v_mfma_f32_16x16x32_bf16 v[60:63], v[120:123], v[76:79], v[60:63]
    s_waitcnt lgkmcnt(9)
    v_mfma_f32_16x16x32_bf16 v[16:19], v[100:103], v[84:87], v[16:19]
    ds_read_b64_tr_b16 v[112:113], v128 offset:1536
    ds_read_b64_tr_b16 v[114:115], v128 offset:1584
    s_waitcnt lgkmcnt(10)
    v_mfma_f32_16x16x32_bf16 v[20:23], v[100:103], v[88:91], v[20:23]
    ds_read_b128 v[64:67], v125 offset:0
    s_waitcnt lgkmcnt(10)
    v_mfma_f32_16x16x32_bf16 v[24:27], v[100:103], v[92:95], v[24:27]
    ds_read_b128 v[68:71], v125 offset:2048
    s_waitcnt lgkmcnt(10)
    v_mfma_f32_16x16x32_bf16 v[28:31], v[100:103], v[96:99], v[28:31]
    ds_read_b128 v[72:75], v125 offset:4096
    s_waitcnt lgkmcnt(5)
    v_cndmask_b32_dpp v108, v80, v108, vcc quad_perm:[2,3,0,1] row_mask:0xf bank_mask:0xf
    v_cndmask_b32_dpp v109, v81, v109, vcc quad_perm:[2,3,0,1] row_mask:0xf bank_mask:0xf
    v_cndmask_b32_dpp v110, v82, v110, vcc quad_perm:[2,3,0,1] row_mask:0xf bank_mask:0xf
    v_cndmask_b32_dpp v111, v83, v111, vcc quad_perm:[2,3,0,1] row_mask:0xf bank_mask:0xf
    ds_read_b128 v[76:79], v125 offset:6144
    v_mfma_f32_16x16x32_bf16 v[32:35], v[104:107], v[84:87], v[32:35]
    ds_read_b64_tr_b16 v[116:117], v128 offset:10784
    ds_read_b64_tr_b16 v[118:119], v128 offset:10832
    v_mfma_f32_16x16x32_bf16 v[36:39], v[104:107], v[88:91], v[36:39]
    ds_read_b64_tr_b16 v[120:121], v129 offset:1536
    ds_read_b64_tr_b16 v[122:123], v129 offset:1584
    v_mfma_f32_16x16x32_bf16 v[40:43], v[104:107], v[92:95], v[40:43]
    ds_read_b64_tr_b16 v[80:81], v133 offset:1536
    ds_read_b64_tr_b16 v[82:83], v133 offset:1584
    v_mfma_f32_16x16x32_bf16 v[44:47], v[104:107], v[96:99], v[44:47]
    v_mfma_f32_16x16x32_bf16 v[48:51], v[108:111], v[84:87], v[48:51]
    v_mfma_f32_16x16x32_bf16 v[52:55], v[108:111], v[88:91], v[52:55]
    v_mfma_f32_16x16x32_bf16 v[56:59], v[108:111], v[92:95], v[56:59]
    v_mfma_f32_16x16x32_bf16 v[60:63], v[108:111], v[96:99], v[60:63]
    s_add_u32 s45, s45, 53376
    s_cmp_eq_u32 s45, 160128
    s_mov_b32 s46, 53376
    s_cselect_b32 s46, 4294860544, s46
    s_cselect_b32 s45, 0, s45
    v_add_u32 v124, s46, v124
    v_add_u32 v125, s46, v125
    v_add_u32 v128, s46, v128
    v_add_u32 v129, s46, v129
    v_add_u32 v133, s46, v133
    s_add_u32 s44, s44, 1
    s_cmp_lt_u32 s44, 9
    s_cbranch_scc1 L_f3_kernel_gloop1
    s_waitcnt lgkmcnt(0)
    v_cndmask_b32_dpp v120, v80, v120, vcc quad_perm:[2,3,0,1] row_mask:0xf bank_mask:0xf
    v_cndmask_b32_dpp v121, v81, v121, vcc quad_perm:[2,3,0,1] row_mask:0xf bank_mask:0xf
    v_cndmask_b32_dpp v122, v82, v122, vcc quad_perm:[2,3,0,1] row_mask:0xf bank_mask:0xf
    v_cndmask_b32_dpp v123, v83, v123, vcc quad_perm:[2,3,0,1] row_mask:0xf bank_mask:0xf
    s_nop 1
    v_mfma_f32_16x16x32_bf16 v[48:51], v[120:123], v[64:67], v[48:51]
    v_mfma_f32_16x16x32_bf16 v[52:55], v[120:123], v[68:71], v[52:55]
    v_mfma_f32_16x16x32_bf16 v[56:59], v[120:123], v[72:75], v[56:59]
    v_mfma_f32_16x16x32_bf16 v[60:63], v[120:123], v[76:79], v[60:63]
    v_mfma_f32_16x16x32_bf16 v[16:19], v[112:115], v[64:67], v[16:19]
    v_mfma_f32_16x16x32_bf16 v[20:23], v[112:115], v[68:71], v[20:23]
    v_mfma_f32_16x16x32_bf16 v[24:27], v[112:115], v[72:75], v[24:27]
    v_mfma_f32_16x16x32_bf16 v[28:31], v[112:115], v[76:79], v[28:31]
    v_mfma_f32_16x16x32_bf16 v[32:35], v[116:119], v[64:67], v[32:35]
    v_mfma_f32_16x16x32_bf16 v[36:39], v[116:119], v[68:71], v[36:39]
    v_mfma_f32_16x16x32_bf16 v[40:43], v[116:119], v[72:75], v[40:43]
    v_mfma_f32_16x16x32_bf16 v[44:47], v[116:119], v[76:79], v[44:47]
    s_lshl_b32 s26, s23, 1
    s_mul_i32 s27, s26, 3584
    s_add_u32 s27, s27, 61952
    v_add_u32 v1, s27, v142
    s_lshl_b32 s27, s26, 10
    s_add_u32 s27, s27, 90624
    v_add_u32 v2, s27, v142
    s_mov_b32 s28, 0x3eae1a93
    s_cmp_eq_u32 s47, 1
    s_cselect_b64 vcc, -1, 0
    v_cndmask_b32 v84, v48, v50, vcc
    v_cndmask_b32 v85, v49, v51, vcc
    v_cndmask_b32 v86, v50, v48, vcc
    v_cndmask_b32 v87, v51, v49, vcc
    v_cvt_pk_bf16_f32 v64, v84, v85
    v_mul_f32 v86, s28, v86
    v_mul_f32 v87, s28, v87
    v_mov_b32 v65, 0x3f80
    v_cvt_pk_bf16_f32 v72, v86, v87
    v_cndmask_b32 v88, v52, v54, vcc
    v_cndmask_b32 v89, v53, v55, vcc
    v_cndmask_b32 v90, v54, v52, vcc
    v_cndmask_b32 v91, v55, v53, vcc
    v_cvt_pk_bf16_f32 v66, v88, v89
    v_mul_f32 v90, s28, v90
    v_mul_f32 v91, s28, v91
    v_mov_b32 v67, 0x3f80
    v_cvt_pk_bf16_f32 v73, v90, v91
    v_cndmask_b32 v92, v56, v58, vcc
    v_cndmask_b32 v93, v57, v59, vcc
    v_cndmask_b32 v94, v58, v56, vcc
    v_cndmask_b32 v95, v59, v57, vcc
    v_cvt_pk_bf16_f32 v68, v92, v93
    v_mul_f32 v94, s28, v94
    v_mul_f32 v95, s28, v95
    v_mov_b32 v69, 0x3f80
    v_cvt_pk_bf16_f32 v74, v94, v95
    v_cndmask_b32 v96, v60, v62, vcc
    v_cndmask_b32 v97, v61, v63, vcc
    v_cndmask_b32 v98, v62, v60, vcc
    v_cndmask_b32 v99, v63, v61, vcc
    v_cvt_pk_bf16_f32 v70, v96, v97
    v_mul_f32 v98, s28, v98
    v_mul_f32 v99, s28, v99
    v_mov_b32 v71, 0x3f80
    v_cvt_pk_bf16_f32 v75, v98, v99
    s_mov_b32 exec_hi, 0
    ds_write_b32 v8, v64 offset:0
    ds_write_b32 v8, v66 offset:64
    ds_write_b32 v9, v68 offset:0
    ds_write_b32 v9, v70 offset:64
    s_mov_b32 exec_hi, -1
    s_mov_b32 exec_lo, 0
    ds_write_b64 v8, v[64:65] offset:0
    ds_write_b64 v8, v[66:67] offset:128
    ds_write_b64 v9, v[68:69] offset:0
    ds_write_b64 v9, v[70:71] offset:128
    s_mov_b32 exec_lo, -1
    s_mov_b32 exec_hi, 0
    ds_write_b32 v12, v72 offset:0
    ds_write_b32 v12, v73 offset:64
    ds_write_b32 v13, v74 offset:0
    ds_write_b32 v13, v75 offset:64
    s_mov_b32 exec_hi, -1
    s_waitcnt lgkmcnt(0)
    s_barrier
    v_and_b32 v4, 15, v0
    v_lshrrev_b32 v5, 5, v0
    v_lshlrev_b32 v6, 2, v5
    v_xor_b32 v4, v4, v6
    v_lshlrev_b32 v4, 4, v4
    v_lshl_add_u32 v4, v5, 9, v4
    v_bfe_u32 v5, v0, 4, 1
    v_lshl_add_u32 v4, v5, 3, v4
    s_lshl_b32 s26, s23, 1
    s_mul_i32 s27, s26, 3584
    s_add_u32 s27, s27, 61952
    v_add_u32 v1, s27, v4
    s_lshl_b32 s27, s26, 10
    s_add_u32 s27, s27, 90624
    v_add_u32 v2, s27, v4
    v_mul_f32 v32, s28, v32
    v_mul_f32 v33, s28, v33
    v_mul_f32 v34, s28, v34
    v_mul_f32 v35, s28, v35
    v_cvt_pk_bf16_f32 v32, v32, v33
    v_cvt_pk_bf16_f32 v33, v34, v35
    ds_write_b64 v2, v[32:33] offset:0
    v_mul_f32 v36, s28, v36
    v_mul_f32 v37, s28, v37
    v_mul_f32 v38, s28, v38
    v_mul_f32 v39, s28, v39
    v_cvt_pk_bf16_f32 v36, v36, v37
    v_cvt_pk_bf16_f32 v37, v38, v39
    ds_write_b64 v2, v[36:37] offset:256
    v_mul_f32 v40, s28, v40
    v_mul_f32 v41, s28, v41
    v_mul_f32 v42, s28, v42
    v_mul_f32 v43, s28, v43
    v_cvt_pk_bf16_f32 v40, v40, v41
    v_cvt_pk_bf16_f32 v41, v42, v43
    ds_write_b64 v2, v[40:41] offset:1024
    v_mul_f32 v44, s28, v44
    v_mul_f32 v45, s28, v45
    v_mul_f32 v46, s28, v46
    v_mul_f32 v47, s28, v47
    v_cvt_pk_bf16_f32 v44, v44, v45
    v_cvt_pk_bf16_f32 v45, v46, v47
    ds_write_b64 v2, v[44:45] offset:1280
    v_mul_f32 v16, s28, v16
    v_mul_f32 v17, s28, v17
    v_mul_f32 v18, s28, v18
    v_mul_f32 v19, s28, v19
    v_cvt_pk_bf16_f32 v16, v16, v17
    v_cvt_pk_bf16_f32 v17, v18, v19
    ds_write_b64 v1, v[16:17] offset:2432
    v_mul_f32 v20, s28, v20
    v_mul_f32 v21, s28, v21
    v_mul_f32 v22, s28, v22
    v_mul_f32 v23, s28, v23
    v_cvt_pk_bf16_f32 v20, v20, v21
    v_cvt_pk_bf16_f32 v21, v22, v23
    ds_write_b64 v1, v[20:21] offset:2688
    v_mul_f32 v24, s28, v24
    v_mul_f32 v25, s28, v25
    v_mul_f32 v26, s28, v26
    v_mul_f32 v27, s28, v27
    v_cvt_pk_bf16_f32 v24, v24, v25
    v_cvt_pk_bf16_f32 v25, v26, v27
    ds_write_b64 v1, v[24:25] offset:6016
    v_mul_f32 v28, s28, v28
    v_mul_f32 v29, s28, v29
    v_mul_f32 v30, s28, v30
    v_mul_f32 v31, s28, v31
    v_cvt_pk_bf16_f32 v28, v28, v29
    v_cvt_pk_bf16_f32 v29, v30, v31
    ds_write_b64 v1, v[28:29] offset:6272
L_f3_kernel_post:
    v_mov_b32 v64, 0
    v_mov_b32 v65, 0
    v_mov_b32 v66, 0
    v_mov_b32 v67, 0
    v_mov_b32 v68, 0
    v_mov_b32 v69, 0
    v_mov_b32 v70, 0
    v_mov_b32 v71, 0
    v_mov_b32 v151, 0
    s_movk_i32 s26, 1024
    s_movk_i32 s28, -1024
    s_movk_i32 s27, 128
    s_movk_i32 s29, -128
    s_cmp_eq_u32 s24, 0
    s_cselect_b32 s26, s26, s28
    s_cselect_b32 s27, s27, s29
    v_add_u32 v6, s26, v149
    v_add_u32 v7, s27, v150
    v_cmp_gt_u32 vcc, 32, v0
    s_nop 1
    v_cndmask_b32 v7, v7, v150, vcc
    s_waitcnt lgkmcnt(0)
    s_barrier
    s_setprio 2
    ds_read_b128 v[48:51], v152 offset:0
    ds_read_b128 v[52:55], v152 offset:3584
    ds_read_b128 v[56:59], v152 offset:16
    ds_read_b128 v[60:63], v152 offset:3600
    ds_read_b32 v150, v7
    s_mov_b32 exec_hi, 0
    ds_read_b128 v[64:67], v152 offset:6016
    ds_read_b128 v[68:71], v152 offset:6032
    s_mov_b32 exec_lo, 0
    s_mov_b32 exec_hi, 0xffff
    ds_read_b32 v64, v153 offset:7040
    ds_read_b32 v68, v153 offset:7044
    s_mov_b32 exec_hi, -1
    ds_read_b32 v48, v153 offset:2304
    ds_read_b32 v52, v153 offset:5888
    ds_read_b32 v56, v153 offset:2308
    ds_read_b32 v60, v153 offset:5892
    s_mov_b32 exec_lo, -1
    ds_read_b64_tr_b16 v[96:97], v154 offset:1024
    ds_read_b64_tr_b16 v[98:99], v154 offset:4608
    ds_read_b64_tr_b16 v[100:101], v155 offset:2048
    ds_read_b64_tr_b16 v[102:103], v155 offset:5632
    ds_read_b64_tr_b16 v[104:105], v154 offset:1040
    ds_read_b64_tr_b16 v[106:107], v154 offset:4624
    ds_read_b64_tr_b16 v[108:109], v155 offset:2056
    ds_read_b64_tr_b16 v[110:111], v155 offset:5640
    s_waitcnt lgkmcnt(8)
    v_mfma_f32_16x16x32_bf16 v[80:83], v[48:51], v[64:67], v[160:163]
    v_mfma_f32_16x16x32_bf16 v[84:87], v[52:55], v[64:67], v[164:167]
    v_mfma_f32_16x16x32_bf16 v[88:91], v[56:59], v[68:71], v[160:163]
    v_mfma_f32_16x16x32_bf16 v[92:95], v[60:63], v[68:71], v[164:167]
    ds_read_b128 v[128:131], v149
    ds_read_b128 v[132:135], v6
    s_nop 2
    v_max3_f32 v2, v80, v81, v82
    s_nop 0
    v_max3_f32 v4, v88, v89, v90
    v_max3_f32 v3, v83, v84, v85
    v_max3_f32 v5, v91, v92, v93
    v_max3_f32 v2, v2, v86, v87
    v_max3_f32 v4, v4, v94, v95
    v_max_f32 v2, v2, v3
    v_max_f32 v4, v4, v5
    v_mov_b32 v3, v2
    v_mov_b32 v5, v4
    s_nop 0
    v_permlane16_swap_b32 v2, v3
    v_permlane16_swap_b32 v4, v5
    v_max_f32 v2, v2, v3
    v_max_f32 v4, v4, v5
    v_mov_b32 v3, v2
    v_mov_b32 v5, v4
    s_nop 0
    v_permlane32_swap_b32 v2, v3
    v_permlane32_swap_b32 v4, v5
    v_max_f32 v2, v2, v3
    v_max_f32 v4, v4, v5
    v_sub_f32 v80, v80, v2
    v_sub_f32 v88, v88, v4
    v_sub_f32 v81, v81, v2
    v_sub_f32 v89, v89, v4
    v_sub_f32 v82, v82, v2
    v_sub_f32 v90, v90, v4
    v_sub_f32 v83, v83, v2
    v_sub_f32 v91, v91, v4
    v_sub_f32 v84, v84, v2
    v_sub_f32 v92, v92, v4
    v_sub_f32 v85, v85, v2
    v_sub_f32 v93, v93, v4
    v_sub_f32 v86, v86, v2
    v_sub_f32 v94, v94, v4
    v_sub_f32 v87, v87, v2
    v_sub_f32 v95, v95, v4
    v_exp_f32 v80, v80
    v_exp_f32 v88, v88
    v_exp_f32 v81, v81
    v_exp_f32 v89, v89
    v_exp_f32 v82, v82
    v_exp_f32 v90, v90
    v_exp_f32 v83, v83
    v_exp_f32 v91, v91
    v_exp_f32 v84, v84
    v_exp_f32 v92, v92
    v_exp_f32 v85, v85
    v_exp_f32 v93, v93
    v_exp_f32 v86, v86
    v_exp_f32 v94, v94
    v_exp_f32 v87, v87
    v_exp_f32 v95, v95
    v_cvt_pk_bf16_f32 v112, v80, v81
    v_cvt_pk_bf16_f32 v116, v88, v89
    v_cvt_pk_bf16_f32 v113, v82, v83
    v_cvt_pk_bf16_f32 v117, v90, v91
    v_cvt_pk_bf16_f32 v114, v84, v85
    v_cvt_pk_bf16_f32 v118, v92, v93
    v_cvt_pk_bf16_f32 v115, v86, v87
    v_cvt_pk_bf16_f32 v119, v94, v95
    s_waitcnt lgkmcnt(0)
    v_mfma_f32_16x16x32_bf16 v[52:55], v[100:103], v[112:115], 0
    v_mfma_f32_16x16x32_bf16 v[60:63], v[108:111], v[116:119], 0
    v_mfma_f32_16x16x32_bf16 v[48:51], v[96:99], v[112:115], 0
    v_mfma_f32_16x16x32_bf16 v[56:59], v[104:107], v[116:119], 0
    s_nop 4
    v_rcp_f32 v2, v54
    v_rcp_f32 v4, v62
    v_mul_f32 v52, v52, v2
    v_mul_f32 v60, v60, v4
    v_mul_f32 v53, v53, v2
    v_mul_f32 v61, v61, v4
    v_cvt_pk_bf16_f32 v52, v52, v53
    v_cvt_pk_bf16_f32 v53, v60, v61
    v_mul_f32 v48, v48, v2
    v_mul_f32 v56, v56, v4
    v_mul_f32 v49, v49, v2
    v_mul_f32 v57, v57, v4
    v_mul_f32 v50, v50, v2
    v_mul_f32 v58, v58, v4
    v_mul_f32 v51, v51, v2
    v_mul_f32 v59, v59, v4
    buffer_store_dwordx2 v[52:53], v157, s[4:7], s38 offen sc1
    v_cvt_pk_bf16_f32 v48, v48, v49
    v_cvt_pk_bf16_f32 v49, v50, v51
    v_cvt_pk_bf16_f32 v50, v56, v57
    v_cvt_pk_bf16_f32 v51, v58, v59
    s_nop 0
    v_permlane16_swap_b32 v48, v50
    v_permlane16_swap_b32 v49, v51
    buffer_store_dwordx4 v[48:51], v156, s[4:7], s35 offen sc1
    ds_read_b32 v84, v143 offset:0
    ds_read_b128 v[80:83], v142 offset:0
    ds_read_b32 v156, v137 offset:0
    ds_read_b128 v[152:155], v136 offset:0
    v_mov_b32 v157, 0x3f80
    v_mov_b32 v85, 0x3f80
    s_waitcnt lgkmcnt(3)
    s_nop 0
    v_mfma_f32_32x32x4_2b_bf16 v[48:79], v[84:85], v[150:151], 0
    s_waitcnt lgkmcnt(2)
    s_nop 15
    s_nop 2
    v_mfma_f32_32x32x16_bf16 v[48:63], v[80:83], v[128:131], v[48:63]
    v_mfma_f32_32x32x16_bf16 v[64:79], v[80:83], v[132:135], v[64:79]
    ds_read_b32 v84, v137 offset:128
    s_nop 9
    v_max3_f32 v1, v48, v49, v50
    v_max3_f32 v2, v51, v52, v53
    v_max3_f32 v1, v1, v54, v55
    v_max3_f32 v2, v2, v56, v57
    v_max3_f32 v1, v1, v58, v59
    v_max3_f32 v2, v2, v60, v61
    v_max3_f32 v1, v1, v62, v63
    v_max_f32 v1, v1, v2
    v_max3_f32 v3, v64, v65, v66
    v_max3_f32 v4, v67, v68, v69
    v_max3_f32 v3, v3, v70, v71
    v_max3_f32 v4, v4, v72, v73
    v_max3_f32 v3, v3, v74, v75
    v_max3_f32 v4, v4, v76, v77
    v_max3_f32 v3, v3, v78, v79
    v_max_f32 v3, v3, v4
    s_nop 1
    v_permlane32_swap_b32 v1, v3
    v_max_f32 v1, v1, v3
    v_cvt_pk_bf16_f32 v151, -v1, 0
    s_waitcnt lgkmcnt(0)
    s_nop 0
    v_mfma_f32_32x32x4_2b_bf16 v[48:79], v[156:157], v[150:151], 0
    s_nop 15
    s_nop 3
    v_mfma_f32_32x32x16_bf16 v[48:63], v[152:155], v[128:131], v[48:63]
    v_mfma_f32_32x32x16_bf16 v[64:79], v[152:155], v[132:135], v[64:79]
    s_mov_b32 s34, 0
    s_mov_b32 s48, 0x4b
    s_setprio 0
    v_mfma_f32_32x32x4_2b_bf16 v[96:127], v[84:85], v[150:151], 0
    ds_read_b128 v[152:155], v136 offset:1024
    s_nop 5
    v_exp_f32 v48, v48
    v_exp_f32 v49, v49
    v_exp_f32 v50, v50
    v_exp_f32 v51, v51
    v_cvt_pk_bf16_f32 v80, v48, v49
    v_cvt_pk_bf16_f32 v81, v50, v51
    s_setprio 1
    v_exp_f32 v52, v52
    v_exp_f32 v53, v53
    v_exp_f32 v54, v54
    v_exp_f32 v55, v55
    v_cvt_pk_bf16_f32 v82, v52, v53
    v_cvt_pk_bf16_f32 v83, v54, v55
    v_exp_f32 v56, v56
    v_exp_f32 v57, v57
    v_exp_f32 v58, v58
    v_exp_f32 v59, v59
    v_cvt_pk_bf16_f32 v84, v56, v57
    v_cvt_pk_bf16_f32 v85, v58, v59
    s_setprio 2
    ds_read_b64_tr_b16 v[160:161], v138 offset:0
    ds_read_b64_tr_b16 v[162:163], v139 offset:0
    v_exp_f32 v60, v60
    v_exp_f32 v61, v61
    v_exp_f32 v62, v62
    v_exp_f32 v63, v63
    v_cvt_pk_bf16_f32 v86, v60, v61
    v_cvt_pk_bf16_f32 v87, v62, v63
    s_waitcnt lgkmcnt(2)
    v_mfma_f32_32x32x16_bf16 v[96:111], v[152:155], v[128:131], v[96:111]
    ds_read_b64_tr_b16 v[164:165], v140 offset:0
    ds_read_b64_tr_b16 v[166:167], v141 offset:0
    v_exp_f32 v64, v64
    v_exp_f32 v65, v65
    v_exp_f32 v66, v66
    v_exp_f32 v67, v67
    v_cvt_pk_bf16_f32 v88, v64, v65
    v_cvt_pk_bf16_f32 v89, v66, v67
    s_setprio 3
    v_mfma_f32_32x32x16_bf16 v[112:127], v[152:155], v[132:135], v[112:127]
    ds_read_b32 v156, v137 offset:256
    v_exp_f32 v68, v68
    v_exp_f32 v69, v69
    v_exp_f32 v70, v70
    v_exp_f32 v71, v71
    v_cvt_pk_bf16_f32 v90, v68, v69
    v_cvt_pk_bf16_f32 v91, v70, v71
    s_waitcnt lgkmcnt(3)
    v_mfma_f32_32x32x16_bf16 v[16:31], v[160:163], v[80:83], 0
    v_exp_f32 v72, v72
    v_exp_f32 v73, v73
    v_exp_f32 v74, v74
    v_exp_f32 v75, v75
    v_cvt_pk_bf16_f32 v92, v72, v73
    v_cvt_pk_bf16_f32 v93, v74, v75
    s_setprio 0
    s_waitcnt lgkmcnt(1)
    v_mfma_f32_32x32x16_bf16 v[16:31], v[164:167], v[84:87], v[16:31]
    v_exp_f32 v76, v76
    v_exp_f32 v77, v77
    v_exp_f32 v78, v78
    v_exp_f32 v79, v79
    v_cvt_pk_bf16_f32 v94, v76, v77
    v_cvt_pk_bf16_f32 v95, v78, v79
    s_waitcnt lgkmcnt(0)
    v_mfma_f32_32x32x4_2b_bf16 v[48:79], v[156:157], v[150:151], 0
    ds_read_b128 v[152:155], v136 offset:2048
    v_exp_f32 v96, v96
    v_exp_f32 v97, v97
    v_exp_f32 v98, v98
    v_exp_f32 v99, v99
    v_cvt_pk_bf16_f32 v80, v96, v97
    v_cvt_pk_bf16_f32 v81, v98, v99
    s_setprio 1
    v_exp_f32 v100, v100
    v_exp_f32 v101, v101
    v_exp_f32 v102, v102
    v_exp_f32 v103, v103
    v_cvt_pk_bf16_f32 v82, v100, v101
    v_cvt_pk_bf16_f32 v83, v102, v103
    v_mfma_f32_32x32x16_bf16 v[32:47], v[160:163], v[88:91], 0
    v_exp_f32 v104, v104
    v_exp_f32 v105, v105
    v_exp_f32 v106, v106
    v_exp_f32 v107, v107
    v_cvt_pk_bf16_f32 v84, v104, v105
    v_cvt_pk_bf16_f32 v85, v106, v107
    s_setprio 2
    v_mfma_f32_32x32x16_bf16 v[32:47], v[164:167], v[92:95], v[32:47]
    ds_read_b64_tr_b16 v[160:161], v138 offset:1280
    ds_read_b64_tr_b16 v[162:163], v139 offset:1280
    v_exp_f32 v108, v108
    v_exp_f32 v109, v109
    v_exp_f32 v110, v110
    v_exp_f32 v111, v111
    v_cvt_pk_bf16_f32 v86, v108, v109
    v_cvt_pk_bf16_f32 v87, v110, v111
    s_waitcnt lgkmcnt(2)
    v_mfma_f32_32x32x16_bf16 v[48:63], v[152:155], v[128:131], v[48:63]
    ds_read_b64_tr_b16 v[164:165], v140 offset:1280
    ds_read_b64_tr_b16 v[166:167], v141 offset:1280
    v_exp_f32 v112, v112
    v_exp_f32 v113, v113
    v_exp_f32 v114, v114
    v_exp_f32 v115, v115
    v_cvt_pk_bf16_f32 v88, v112, v113
    v_cvt_pk_bf16_f32 v89, v114, v115
    s_setprio 3
    v_mfma_f32_32x32x16_bf16 v[64:79], v[152:155], v[132:135], v[64:79]
    ds_read_b32 v156, v137 offset:384
    v_exp_f32 v116, v116
    v_exp_f32 v117, v117
    v_exp_f32 v118, v118
    v_exp_f32 v119, v119
    v_cvt_pk_bf16_f32 v90, v116, v117
    v_cvt_pk_bf16_f32 v91, v118, v119
    s_waitcnt lgkmcnt(3)
    v_mfma_f32_32x32x16_bf16 v[16:31], v[160:163], v[80:83], v[16:31]
    v_exp_f32 v120, v120
    v_exp_f32 v121, v121
    v_exp_f32 v122, v122
    v_exp_f32 v123, v123
    v_cvt_pk_bf16_f32 v92, v120, v121
    v_cvt_pk_bf16_f32 v93, v122, v123
    s_setprio 0
    s_waitcnt lgkmcnt(1)
    v_mfma_f32_32x32x16_bf16 v[16:31], v[164:167], v[84:87], v[16:31]
    v_exp_f32 v124, v124
    v_exp_f32 v125, v125
    v_exp_f32 v126, v126
    v_exp_f32 v127, v127
    v_cvt_pk_bf16_f32 v94, v124, v125
    v_cvt_pk_bf16_f32 v95, v126, v127
    s_waitcnt lgkmcnt(0)
    v_mfma_f32_32x32x4_2b_bf16 v[96:127], v[156:157], v[150:151], 0
    ds_read_b128 v[152:155], v136 offset:3072
    v_exp_f32 v48, v48
    v_exp_f32 v49, v49
    v_exp_f32 v50, v50
    v_exp_f32 v51, v51
    v_cvt_pk_bf16_f32 v80, v48, v49
    v_cvt_pk_bf16_f32 v81, v50, v51
    s_setprio 1
    v_exp_f32 v52, v52
    v_exp_f32 v53, v53
    v_exp_f32 v54, v54
    v_exp_f32 v55, v55
    v_cvt_pk_bf16_f32 v82, v52, v53
    v_cvt_pk_bf16_f32 v83, v54, v55
    v_mfma_f32_32x32x16_bf16 v[32:47], v[160:163], v[88:91], v[32:47]
    v_exp_f32 v56, v56
    v_exp_f32 v57, v57
    v_exp_f32 v58, v58
    v_exp_f32 v59, v59
    v_cvt_pk_bf16_f32 v84, v56, v57
    v_cvt_pk_bf16_f32 v85, v58, v59
    s_setprio 2
    v_mfma_f32_32x32x16_bf16 v[32:47], v[164:167], v[92:95], v[32:47]
    ds_read_b64_tr_b16 v[160:161], v138 offset:2560
    ds_read_b64_tr_b16 v[162:163], v139 offset:2560
    v_exp_f32 v60, v60
    v_exp_f32 v61, v61
    v_exp_f32 v62, v62
    v_exp_f32 v63, v63
    v_cvt_pk_bf16_f32 v86, v60, v61
    v_cvt_pk_bf16_f32 v87, v62, v63
    s_waitcnt lgkmcnt(2)
    v_mfma_f32_32x32x16_bf16 v[96:111], v[152:155], v[128:131], v[96:111]
    ds_read_b64_tr_b16 v[164:165], v140 offset:2560
    ds_read_b64_tr_b16 v[166:167], v141 offset:2560
    v_exp_f32 v64, v64
    v_exp_f32 v65, v65
    v_exp_f32 v66, v66
    v_exp_f32 v67, v67
    v_cvt_pk_bf16_f32 v88, v64, v65
    v_cvt_pk_bf16_f32 v89, v66, v67
    s_setprio 3
    v_mfma_f32_32x32x16_bf16 v[112:127], v[152:155], v[132:135], v[112:127]
    v_exp_f32 v68, v68
    v_exp_f32 v69, v69
    v_exp_f32 v70, v70
    v_exp_f32 v71, v71
    v_cvt_pk_bf16_f32 v90, v68, v69
    v_cvt_pk_bf16_f32 v91, v70, v71
    s_waitcnt lgkmcnt(2)
    v_mfma_f32_32x32x16_bf16 v[16:31], v[160:163], v[80:83], v[16:31]
    v_exp_f32 v72, v72
    v_exp_f32 v73, v73
    v_exp_f32 v74, v74
    v_exp_f32 v75, v75
    v_cvt_pk_bf16_f32 v92, v72, v73
    v_cvt_pk_bf16_f32 v93, v74, v75
    s_setprio 0
    s_waitcnt lgkmcnt(0)
    v_mfma_f32_32x32x16_bf16 v[16:31], v[164:167], v[84:87], v[16:31]
    v_exp_f32 v76, v76
    v_exp_f32 v77, v77
    v_exp_f32 v78, v78
    v_exp_f32 v79, v79
    v_cvt_pk_bf16_f32 v94, v76, v77
    v_cvt_pk_bf16_f32 v95, v78, v79
    s_waitcnt vmcnt(0)
    s_barrier
    ds_read_b32 v156, v137 offset:19456
    ds_read_b128 v[152:155], v136 offset:19456
    v_exp_f32 v96, v96
    v_exp_f32 v97, v97
    v_exp_f32 v98, v98
    v_exp_f32 v99, v99
    v_cvt_pk_bf16_f32 v80, v96, v97
    v_cvt_pk_bf16_f32 v81, v98, v99
    s_setprio 1
    s_waitcnt lgkmcnt(1)
    v_mfma_f32_32x32x4_2b_bf16 v[48:79], v[156:157], v[150:151], 0
    v_exp_f32 v100, v100
    v_exp_f32 v101, v101
    v_exp_f32 v102, v102
    v_exp_f32 v103, v103
    v_cvt_pk_bf16_f32 v82, v100, v101
    v_cvt_pk_bf16_f32 v83, v102, v103
    v_mfma_f32_32x32x16_bf16 v[32:47], v[160:163], v[88:91], v[32:47]
    v_exp_f32 v104, v104
    v_exp_f32 v105, v105
    v_exp_f32 v106, v106
    v_exp_f32 v107, v107
    v_cvt_pk_bf16_f32 v84, v104, v105
    v_cvt_pk_bf16_f32 v85, v106, v107
    s_setprio 2
    v_mfma_f32_32x32x16_bf16 v[32:47], v[164:167], v[92:95], v[32:47]
    ds_read_b64_tr_b16 v[160:161], v138 offset:3840
    ds_read_b64_tr_b16 v[162:163], v139 offset:3840
    v_exp_f32 v108, v108
    v_exp_f32 v109, v109
    v_exp_f32 v110, v110
    v_exp_f32 v111, v111
    v_cvt_pk_bf16_f32 v86, v108, v109
    v_cvt_pk_bf16_f32 v87, v110, v111
    s_waitcnt lgkmcnt(2)
    v_mfma_f32_32x32x16_bf16 v[48:63], v[152:155], v[128:131], v[48:63]
    ds_read_b64_tr_b16 v[164:165], v140 offset:3840
    ds_read_b64_tr_b16 v[166:167], v141 offset:3840
    v_exp_f32 v112, v112
    v_exp_f32 v113, v113
    v_exp_f32 v114, v114
    v_exp_f32 v115, v115
    v_cvt_pk_bf16_f32 v88, v112, v113
    v_cvt_pk_bf16_f32 v89, v114, v115
    s_setprio 3
    v_mfma_f32_32x32x16_bf16 v[64:79], v[152:155], v[132:135], v[64:79]
    ds_read_b32 v156, v137 offset:19584
    v_exp_f32 v116, v116
    v_exp_f32 v117, v117
    v_exp_f32 v118, v118
    v_exp_f32 v119, v119
    v_cvt_pk_bf16_f32 v90, v116, v117
    v_cvt_pk_bf16_f32 v91, v118, v119
    s_waitcnt lgkmcnt(3)
    v_mfma_f32_32x32x16_bf16 v[16:31], v[160:163], v[80:83], v[16:31]
    v_exp_f32 v120, v120
    v_exp_f32 v121, v121
    v_exp_f32 v122, v122
    v_exp_f32 v123, v123
    v_cvt_pk_bf16_f32 v92, v120, v121
    v_cvt_pk_bf16_f32 v93, v122, v123
    s_setprio 0
    s_waitcnt lgkmcnt(1)
    v_mfma_f32_32x32x16_bf16 v[16:31], v[164:167], v[84:87], v[16:31]
    v_exp_f32 v124, v124
    v_exp_f32 v125, v125
    v_exp_f32 v126, v126
    v_exp_f32 v127, v127
    v_cvt_pk_bf16_f32 v94, v124, v125
    v_cvt_pk_bf16_f32 v95, v126, v127
    s_waitcnt lgkmcnt(0)
    v_mfma_f32_32x32x4_2b_bf16 v[96:127], v[156:157], v[150:151], 0
    ds_read_b128 v[152:155], v136 offset:20480
    v_exp_f32 v48, v48
    v_exp_f32 v49, v49
    v_exp_f32 v50, v50
    v_exp_f32 v51, v51
    v_cvt_pk_bf16_f32 v80, v48, v49
    v_cvt_pk_bf16_f32 v81, v50, v51
    s_setprio 1
    v_exp_f32 v52, v52
    v_exp_f32 v53, v53
    v_exp_f32 v54, v54
    v_exp_f32 v55, v55
    v_cvt_pk_bf16_f32 v82, v52, v53
    v_cvt_pk_bf16_f32 v83, v54, v55
    v_mfma_f32_32x32x16_bf16 v[32:47], v[160:163], v[88:91], v[32:47]
    v_exp_f32 v56, v56
    v_exp_f32 v57, v57
    v_exp_f32 v58, v58
    v_exp_f32 v59, v59
    v_cvt_pk_bf16_f32 v84, v56, v57
    v_cvt_pk_bf16_f32 v85, v58, v59
    s_setprio 2
    v_mfma_f32_32x32x16_bf16 v[32:47], v[164:167], v[92:95], v[32:47]
    ds_read_b64_tr_b16 v[160:161], v138 offset:19456
    ds_read_b64_tr_b16 v[162:163], v139 offset:19456
    v_exp_f32 v60, v60
    v_exp_f32 v61, v61
    v_exp_f32 v62, v62
    v_exp_f32 v63, v63
    v_cvt_pk_bf16_f32 v86, v60, v61
    v_cvt_pk_bf16_f32 v87, v62, v63
    s_waitcnt lgkmcnt(2)
    v_mfma_f32_32x32x16_bf16 v[96:111], v[152:155], v[128:131], v[96:111]
    ds_read_b64_tr_b16 v[164:165], v140 offset:19456
    ds_read_b64_tr_b16 v[166:167], v141 offset:19456
    v_exp_f32 v64, v64
    v_exp_f32 v65, v65
    v_exp_f32 v66, v66
    v_exp_f32 v67, v67
    v_cvt_pk_bf16_f32 v88, v64, v65
    v_cvt_pk_bf16_f32 v89, v66, v67
    s_setprio 3
    v_mfma_f32_32x32x16_bf16 v[112:127], v[152:155], v[132:135], v[112:127]
    ds_read_b32 v156, v137 offset:19712
    v_exp_f32 v68, v68
    v_exp_f32 v69, v69
    v_exp_f32 v70, v70
    v_exp_f32 v71, v71
    v_cvt_pk_bf16_f32 v90, v68, v69
    v_cvt_pk_bf16_f32 v91, v70, v71
    s_waitcnt lgkmcnt(3)
    v_mfma_f32_32x32x16_bf16 v[16:31], v[160:163], v[80:83], v[16:31]
    v_exp_f32 v72, v72
    v_exp_f32 v73, v73
    v_exp_f32 v74, v74
    v_exp_f32 v75, v75
    v_cvt_pk_bf16_f32 v92, v72, v73
    v_cvt_pk_bf16_f32 v93, v74, v75
    s_setprio 0
    s_waitcnt lgkmcnt(1)
    v_mfma_f32_32x32x16_bf16 v[16:31], v[164:167], v[84:87], v[16:31]
    v_exp_f32 v76, v76
    v_exp_f32 v77, v77
    v_exp_f32 v78, v78
    v_exp_f32 v79, v79
    v_cvt_pk_bf16_f32 v94, v76, v77
    v_cvt_pk_bf16_f32 v95, v78, v79
    s_waitcnt lgkmcnt(0)
    v_mfma_f32_32x32x4_2b_bf16 v[48:79], v[156:157], v[150:151], 0
    ds_read_b128 v[152:155], v136 offset:21504
    v_exp_f32 v96, v96
    v_exp_f32 v97, v97
    v_exp_f32 v98, v98
    v_exp_f32 v99, v99
    v_cvt_pk_bf16_f32 v80, v96, v97
    v_cvt_pk_bf16_f32 v81, v98, v99
    s_setprio 1
    v_exp_f32 v100, v100
    v_exp_f32 v101, v101
    v_exp_f32 v102, v102
    v_exp_f32 v103, v103
    v_cvt_pk_bf16_f32 v82, v100, v101
    v_cvt_pk_bf16_f32 v83, v102, v103
    v_mfma_f32_32x32x16_bf16 v[32:47], v[160:163], v[88:91], v[32:47]
    v_exp_f32 v104, v104
    v_exp_f32 v105, v105
    v_exp_f32 v106, v106
    v_exp_f32 v107, v107
    v_cvt_pk_bf16_f32 v84, v104, v105
    v_cvt_pk_bf16_f32 v85, v106, v107
    s_setprio 2
    v_mfma_f32_32x32x16_bf16 v[32:47], v[164:167], v[92:95], v[32:47]
    ds_read_b64_tr_b16 v[160:161], v138 offset:20736
    ds_read_b64_tr_b16 v[162:163], v139 offset:20736
    v_exp_f32 v108, v108
    v_exp_f32 v109, v109
    v_exp_f32 v110, v110
    v_exp_f32 v111, v111
    v_cvt_pk_bf16_f32 v86, v108, v109
    v_cvt_pk_bf16_f32 v87, v110, v111
    s_waitcnt lgkmcnt(2)
    v_mfma_f32_32x32x16_bf16 v[48:63], v[152:155], v[128:131], v[48:63]
    ds_read_b64_tr_b16 v[164:165], v140 offset:20736
    ds_read_b64_tr_b16 v[166:167], v141 offset:20736
    v_exp_f32 v112, v112
    v_exp_f32 v113, v113
    v_exp_f32 v114, v114
    v_exp_f32 v115, v115
    v_cvt_pk_bf16_f32 v88, v112, v113
    v_cvt_pk_bf16_f32 v89, v114, v115
    s_setprio 3
    v_mfma_f32_32x32x16_bf16 v[64:79], v[152:155], v[132:135], v[64:79]
    ds_read_b32 v156, v137 offset:19840
    v_exp_f32 v116, v116
    v_exp_f32 v117, v117
    v_exp_f32 v118, v118
    v_exp_f32 v119, v119
    v_cvt_pk_bf16_f32 v90, v116, v117
    v_cvt_pk_bf16_f32 v91, v118, v119
    s_waitcnt lgkmcnt(3)
    v_mfma_f32_32x32x16_bf16 v[16:31], v[160:163], v[80:83], v[16:31]
    v_exp_f32 v120, v120
    v_exp_f32 v121, v121
    v_exp_f32 v122, v122
    v_exp_f32 v123, v123
    v_cvt_pk_bf16_f32 v92, v120, v121
    v_cvt_pk_bf16_f32 v93, v122, v123
    s_setprio 0
    s_waitcnt lgkmcnt(1)
    v_mfma_f32_32x32x16_bf16 v[16:31], v[164:167], v[84:87], v[16:31]
    v_exp_f32 v124, v124
    v_exp_f32 v125, v125
    v_exp_f32 v126, v126
    v_exp_f32 v127, v127
    v_cvt_pk_bf16_f32 v94, v124, v125
    v_cvt_pk_bf16_f32 v95, v126, v127
    s_waitcnt lgkmcnt(0)
    v_mfma_f32_32x32x4_2b_bf16 v[96:127], v[156:157], v[150:151], 0
    ds_read_b128 v[152:155], v136 offset:22528
    v_exp_f32 v48, v48
    v_exp_f32 v49, v49
    v_exp_f32 v50, v50
    v_exp_f32 v51, v51
    v_cvt_pk_bf16_f32 v80, v48, v49
    v_cvt_pk_bf16_f32 v81, v50, v51
    s_setprio 1
    v_exp_f32 v52, v52
    v_exp_f32 v53, v53
    v_exp_f32 v54, v54
    v_exp_f32 v55, v55
    v_cvt_pk_bf16_f32 v82, v52, v53
    v_cvt_pk_bf16_f32 v83, v54, v55
    v_mfma_f32_32x32x16_bf16 v[32:47], v[160:163], v[88:91], v[32:47]
    v_exp_f32 v56, v56
    v_exp_f32 v57, v57
    v_exp_f32 v58, v58
    v_exp_f32 v59, v59
    v_cvt_pk_bf16_f32 v84, v56, v57
    v_cvt_pk_bf16_f32 v85, v58, v59
    s_setprio 2
    v_mfma_f32_32x32x16_bf16 v[32:47], v[164:167], v[92:95], v[32:47]
    ds_read_b64_tr_b16 v[160:161], v138 offset:22016
    ds_read_b64_tr_b16 v[162:163], v139 offset:22016
    v_exp_f32 v60, v60
    v_exp_f32 v61, v61
    v_exp_f32 v62, v62
    v_exp_f32 v63, v63
    v_cvt_pk_bf16_f32 v86, v60, v61
    v_cvt_pk_bf16_f32 v87, v62, v63
    s_waitcnt lgkmcnt(2)
    v_mfma_f32_32x32x16_bf16 v[96:111], v[152:155], v[128:131], v[96:111]
    ds_read_b64_tr_b16 v[164:165], v140 offset:22016
    ds_read_b64_tr_b16 v[166:167], v141 offset:22016
    v_exp_f32 v64, v64
    v_exp_f32 v65, v65
    v_exp_f32 v66, v66
    v_exp_f32 v67, v67
    v_cvt_pk_bf16_f32 v88, v64, v65
    v_cvt_pk_bf16_f32 v89, v66, v67
    s_setprio 3
    v_mfma_f32_32x32x16_bf16 v[112:127], v[152:155], v[132:135], v[112:127]
    v_exp_f32 v68, v68
    v_exp_f32 v69, v69
    v_exp_f32 v70, v70
    v_exp_f32 v71, v71
    v_cvt_pk_bf16_f32 v90, v68, v69
    v_cvt_pk_bf16_f32 v91, v70, v71
    s_waitcnt lgkmcnt(2)
    v_mfma_f32_32x32x16_bf16 v[16:31], v[160:163], v[80:83], v[16:31]
    v_exp_f32 v72, v72
    v_exp_f32 v73, v73
    v_exp_f32 v74, v74
    v_exp_f32 v75, v75
    v_cvt_pk_bf16_f32 v92, v72, v73
    v_cvt_pk_bf16_f32 v93, v74, v75
    s_setprio 0
    s_waitcnt lgkmcnt(0)
    v_mfma_f32_32x32x16_bf16 v[16:31], v[164:167], v[84:87], v[16:31]
    v_exp_f32 v76, v76
    v_exp_f32 v77, v77
    v_exp_f32 v78, v78
    v_exp_f32 v79, v79
    v_cvt_pk_bf16_f32 v94, v76, v77
    v_cvt_pk_bf16_f32 v95, v78, v79
    s_waitcnt vmcnt(0)
    s_barrier
    ds_read_b32 v156, v137 offset:38912
    ds_read_b128 v[152:155], v136 offset:38912
    v_exp_f32 v96, v96
    v_exp_f32 v97, v97
    v_exp_f32 v98, v98
    v_exp_f32 v99, v99
    v_cvt_pk_bf16_f32 v80, v96, v97
    v_cvt_pk_bf16_f32 v81, v98, v99
    s_setprio 1
    s_waitcnt lgkmcnt(1)
    v_mfma_f32_32x32x4_2b_bf16 v[48:79], v[156:157], v[150:151], 0
    v_exp_f32 v100, v100
    v_exp_f32 v101, v101
    v_exp_f32 v102, v102
    v_exp_f32 v103, v103
    v_cvt_pk_bf16_f32 v82, v100, v101
    v_cvt_pk_bf16_f32 v83, v102, v103
    v_mfma_f32_32x32x16_bf16 v[32:47], v[160:163], v[88:91], v[32:47]
    v_exp_f32 v104, v104
    v_exp_f32 v105, v105
    v_exp_f32 v106, v106
    v_exp_f32 v107, v107
    v_cvt_pk_bf16_f32 v84, v104, v105
    v_cvt_pk_bf16_f32 v85, v106, v107
    s_setprio 2
    v_mfma_f32_32x32x16_bf16 v[32:47], v[164:167], v[92:95], v[32:47]
    ds_read_b64_tr_b16 v[160:161], v138 offset:23296
    ds_read_b64_tr_b16 v[162:163], v139 offset:23296
    v_exp_f32 v108, v108
    v_exp_f32 v109, v109
    v_exp_f32 v110, v110
    v_exp_f32 v111, v111
    v_cvt_pk_bf16_f32 v86, v108, v109
    v_cvt_pk_bf16_f32 v87, v110, v111
    s_waitcnt lgkmcnt(2)
    v_mfma_f32_32x32x16_bf16 v[48:63], v[152:155], v[128:131], v[48:63]
    ds_read_b64_tr_b16 v[164:165], v140 offset:23296
    ds_read_b64_tr_b16 v[166:167], v141 offset:23296
    v_exp_f32 v112, v112
    v_exp_f32 v113, v113
    v_exp_f32 v114, v114
    v_exp_f32 v115, v115
    v_cvt_pk_bf16_f32 v88, v112, v113
    v_cvt_pk_bf16_f32 v89, v114, v115
    s_setprio 3
    v_mfma_f32_32x32x16_bf16 v[64:79], v[152:155], v[132:135], v[64:79]
    ds_read_b32 v156, v137 offset:39040
    v_exp_f32 v116, v116
    v_exp_f32 v117, v117
    v_exp_f32 v118, v118
    v_exp_f32 v119, v119
    v_cvt_pk_bf16_f32 v90, v116, v117
    v_cvt_pk_bf16_f32 v91, v118, v119
    s_waitcnt lgkmcnt(3)
    v_mfma_f32_32x32x16_bf16 v[16:31], v[160:163], v[80:83], v[16:31]
    v_exp_f32 v120, v120
    v_exp_f32 v121, v121
    v_exp_f32 v122, v122
    v_exp_f32 v123, v123
    v_cvt_pk_bf16_f32 v92, v120, v121
    v_cvt_pk_bf16_f32 v93, v122, v123
    s_setprio 0
    s_waitcnt lgkmcnt(1)
    v_mfma_f32_32x32x16_bf16 v[16:31], v[164:167], v[84:87], v[16:31]
    v_exp_f32 v124, v124
    v_exp_f32 v125, v125
    v_exp_f32 v126, v126
    v_exp_f32 v127, v127
    v_cvt_pk_bf16_f32 v94, v124, v125
    v_cvt_pk_bf16_f32 v95, v126, v127
    s_waitcnt lgkmcnt(0)
    v_mfma_f32_32x32x4_2b_bf16 v[96:127], v[156:157], v[150:151], 0
    ds_read_b128 v[152:155], v136 offset:39936
    v_exp_f32 v48, v48
    v_exp_f32 v49, v49
    v_exp_f32 v50, v50
    v_exp_f32 v51, v51
    v_cvt_pk_bf16_f32 v80, v48, v49
    v_cvt_pk_bf16_f32 v81, v50, v51
    s_setprio 1
    v_exp_f32 v52, v52
    v_exp_f32 v53, v53
    v_exp_f32 v54, v54
    v_exp_f32 v55, v55
    v_cvt_pk_bf16_f32 v82, v52, v53
    v_cvt_pk_bf16_f32 v83, v54, v55
    v_mfma_f32_32x32x16_bf16 v[32:47], v[160:163], v[88:91], v[32:47]
    v_exp_f32 v56, v56
    v_exp_f32 v57, v57
    v_exp_f32 v58, v58
    v_exp_f32 v59, v59
    v_cvt_pk_bf16_f32 v84, v56, v57
    v_cvt_pk_bf16_f32 v85, v58, v59
    s_setprio 2
    v_mfma_f32_32x32x16_bf16 v[32:47], v[164:167], v[92:95], v[32:47]
    ds_read_b64_tr_b16 v[160:161], v138 offset:38912
    ds_read_b64_tr_b16 v[162:163], v139 offset:38912
    v_exp_f32 v60, v60
    v_exp_f32 v61, v61
    v_exp_f32 v62, v62
    v_exp_f32 v63, v63
    v_cvt_pk_bf16_f32 v86, v60, v61
    v_cvt_pk_bf16_f32 v87, v62, v63
    s_waitcnt lgkmcnt(2)
    v_mfma_f32_32x32x16_bf16 v[96:111], v[152:155], v[128:131], v[96:111]
    ds_read_b64_tr_b16 v[164:165], v140 offset:38912
    ds_read_b64_tr_b16 v[166:167], v141 offset:38912
    v_exp_f32 v64, v64
    v_exp_f32 v65, v65
    v_exp_f32 v66, v66
    v_exp_f32 v67, v67
    v_cvt_pk_bf16_f32 v88, v64, v65
    v_cvt_pk_bf16_f32 v89, v66, v67
    s_setprio 3
    v_mfma_f32_32x32x16_bf16 v[112:127], v[152:155], v[132:135], v[112:127]
    ds_read_b32 v156, v137 offset:39168
    v_exp_f32 v68, v68
    v_exp_f32 v69, v69
    v_exp_f32 v70, v70
    v_exp_f32 v71, v71
    v_cvt_pk_bf16_f32 v90, v68, v69
    v_cvt_pk_bf16_f32 v91, v70, v71
    s_waitcnt lgkmcnt(3)
    v_mfma_f32_32x32x16_bf16 v[16:31], v[160:163], v[80:83], v[16:31]
    v_exp_f32 v72, v72
    v_exp_f32 v73, v73
    v_exp_f32 v74, v74
    v_exp_f32 v75, v75
    v_cvt_pk_bf16_f32 v92, v72, v73
    v_cvt_pk_bf16_f32 v93, v74, v75
    s_setprio 0
    s_waitcnt lgkmcnt(1)
    v_mfma_f32_32x32x16_bf16 v[16:31], v[164:167], v[84:87], v[16:31]
    v_exp_f32 v76, v76
    v_exp_f32 v77, v77
    v_exp_f32 v78, v78
    v_exp_f32 v79, v79
    v_cvt_pk_bf16_f32 v94, v76, v77
    v_cvt_pk_bf16_f32 v95, v78, v79
    s_waitcnt lgkmcnt(0)
    v_mfma_f32_32x32x4_2b_bf16 v[48:79], v[156:157], v[150:151], 0
    ds_read_b128 v[152:155], v136 offset:40960
    v_exp_f32 v96, v96
    v_exp_f32 v97, v97
    v_exp_f32 v98, v98
    v_exp_f32 v99, v99
    v_cvt_pk_bf16_f32 v80, v96, v97
    v_cvt_pk_bf16_f32 v81, v98, v99
    s_setprio 1
    v_exp_f32 v100, v100
    v_exp_f32 v101, v101
    v_exp_f32 v102, v102
    v_exp_f32 v103, v103
    v_cvt_pk_bf16_f32 v82, v100, v101
    v_cvt_pk_bf16_f32 v83, v102, v103
    v_mfma_f32_32x32x16_bf16 v[32:47], v[160:163], v[88:91], v[32:47]
    v_exp_f32 v104, v104
    v_exp_f32 v105, v105
    v_exp_f32 v106, v106
    v_exp_f32 v107, v107
    v_cvt_pk_bf16_f32 v84, v104, v105
    v_cvt_pk_bf16_f32 v85, v106, v107
    s_setprio 2
    v_mfma_f32_32x32x16_bf16 v[32:47], v[164:167], v[92:95], v[32:47]
    ds_read_b64_tr_b16 v[160:161], v138 offset:40192
    ds_read_b64_tr_b16 v[162:163], v139 offset:40192
    v_exp_f32 v108, v108
    v_exp_f32 v109, v109
    v_exp_f32 v110, v110
    v_exp_f32 v111, v111
    v_cvt_pk_bf16_f32 v86, v108, v109
    v_cvt_pk_bf16_f32 v87, v110, v111
    s_waitcnt lgkmcnt(2)
    v_mfma_f32_32x32x16_bf16 v[48:63], v[152:155], v[128:131], v[48:63]
    ds_read_b64_tr_b16 v[164:165], v140 offset:40192
    ds_read_b64_tr_b16 v[166:167], v141 offset:40192
    v_exp_f32 v112, v112
    v_exp_f32 v113, v113
    v_exp_f32 v114, v114
    v_exp_f32 v115, v115
    v_cvt_pk_bf16_f32 v88, v112, v113
    v_cvt_pk_bf16_f32 v89, v114, v115
    s_setprio 3
    v_mfma_f32_32x32x16_bf16 v[64:79], v[152:155], v[132:135], v[64:79]
    ds_read_b32 v156, v137 offset:39296
    v_exp_f32 v116, v116
    v_exp_f32 v117, v117
    v_exp_f32 v118, v118
    v_exp_f32 v119, v119
    v_cvt_pk_bf16_f32 v90, v116, v117
    v_cvt_pk_bf16_f32 v91, v118, v119
    s_waitcnt lgkmcnt(3)
    v_mfma_f32_32x32x16_bf16 v[16:31], v[160:163], v[80:83], v[16:31]
    v_exp_f32 v120, v120
    v_exp_f32 v121, v121
    v_exp_f32 v122, v122
    v_exp_f32 v123, v123
    v_cvt_pk_bf16_f32 v92, v120, v121
    v_cvt_pk_bf16_f32 v93, v122, v123
    s_setprio 0
    s_waitcnt lgkmcnt(1)
    v_mfma_f32_32x32x16_bf16 v[16:31], v[164:167], v[84:87], v[16:31]
    v_exp_f32 v124, v124
    v_exp_f32 v125, v125
    v_exp_f32 v126, v126
    v_exp_f32 v127, v127
    v_cvt_pk_bf16_f32 v94, v124, v125
    v_cvt_pk_bf16_f32 v95, v126, v127
    s_waitcnt lgkmcnt(0)
    v_mfma_f32_32x32x4_2b_bf16 v[96:127], v[156:157], v[150:151], 0
    ds_read_b128 v[152:155], v136 offset:41984
    v_exp_f32 v48, v48
    v_exp_f32 v49, v49
    v_exp_f32 v50, v50
    v_exp_f32 v51, v51
    v_cvt_pk_bf16_f32 v80, v48, v49
    v_cvt_pk_bf16_f32 v81, v50, v51
    s_setprio 1
    v_exp_f32 v52, v52
    v_exp_f32 v53, v53
    v_exp_f32 v54, v54
    v_exp_f32 v55, v55
    v_cvt_pk_bf16_f32 v82, v52, v53
    v_cvt_pk_bf16_f32 v83, v54, v55
    v_mfma_f32_32x32x16_bf16 v[32:47], v[160:163], v[88:91], v[32:47]
    v_exp_f32 v56, v56
    v_exp_f32 v57, v57
    v_exp_f32 v58, v58
    v_exp_f32 v59, v59
    v_cvt_pk_bf16_f32 v84, v56, v57
    v_cvt_pk_bf16_f32 v85, v58, v59
    s_setprio 2
    v_mfma_f32_32x32x16_bf16 v[32:47], v[164:167], v[92:95], v[32:47]
    ds_read_b64_tr_b16 v[160:161], v138 offset:41472
    ds_read_b64_tr_b16 v[162:163], v139 offset:41472
    v_exp_f32 v60, v60
    v_exp_f32 v61, v61
    v_exp_f32 v62, v62
    v_exp_f32 v63, v63
    v_cvt_pk_bf16_f32 v86, v60, v61
    v_cvt_pk_bf16_f32 v87, v62, v63
    s_waitcnt lgkmcnt(2)
    v_mfma_f32_32x32x16_bf16 v[96:111], v[152:155], v[128:131], v[96:111]
    ds_read_b64_tr_b16 v[164:165], v140 offset:41472
    ds_read_b64_tr_b16 v[166:167], v141 offset:41472
    v_exp_f32 v64, v64
    v_exp_f32 v65, v65
    v_exp_f32 v66, v66
    v_exp_f32 v67, v67
    v_cvt_pk_bf16_f32 v88, v64, v65
    v_cvt_pk_bf16_f32 v89, v66, v67
    s_setprio 3
    v_mfma_f32_32x32x16_bf16 v[112:127], v[152:155], v[132:135], v[112:127]
    ds_read_b32 v156, v137 offset:58368
    v_exp_f32 v68, v68
    v_exp_f32 v69, v69
    v_exp_f32 v70, v70
    v_exp_f32 v71, v71
    v_cvt_pk_bf16_f32 v90, v68, v69
    v_cvt_pk_bf16_f32 v91, v70, v71
    s_waitcnt lgkmcnt(3)
    v_mfma_f32_32x32x16_bf16 v[16:31], v[160:163], v[80:83], v[16:31]
    v_exp_f32 v72, v72
    v_exp_f32 v73, v73
    v_exp_f32 v74, v74
    v_exp_f32 v75, v75
    v_cvt_pk_bf16_f32 v92, v72, v73
    v_cvt_pk_bf16_f32 v93, v74, v75
    s_setprio 0
    s_waitcnt lgkmcnt(1)
    v_mfma_f32_32x32x16_bf16 v[16:31], v[164:167], v[84:87], v[16:31]
    v_exp_f32 v76, v76
    v_exp_f32 v77, v77
    v_exp_f32 v78, v78
    v_exp_f32 v79, v79
    v_cvt_pk_bf16_f32 v94, v76, v77
    v_cvt_pk_bf16_f32 v95, v78, v79
    s_waitcnt lgkmcnt(0)
    v_mfma_f32_32x32x4_2b_bf16 v[48:79], v[156:157], v[150:151], 0
    ds_read_b128 v[152:155], v136 offset:58368
    v_exp_f32 v96, v96
    v_exp_f32 v97, v97
    v_exp_f32 v98, v98
    v_exp_f32 v99, v99
    v_cvt_pk_bf16_f32 v80, v96, v97
    v_cvt_pk_bf16_f32 v81, v98, v99
    s_setprio 1
    v_exp_f32 v100, v100
    v_exp_f32 v101, v101
    v_exp_f32 v102, v102
    v_exp_f32 v103, v103
    v_cvt_pk_bf16_f32 v82, v100, v101
    v_cvt_pk_bf16_f32 v83, v102, v103
    v_mfma_f32_32x32x16_bf16 v[32:47], v[160:163], v[88:91], v[32:47]
    v_exp_f32 v104, v104
    v_exp_f32 v105, v105
    v_exp_f32 v106, v106
    v_exp_f32 v107, v107
    v_cvt_pk_bf16_f32 v84, v104, v105
    v_cvt_pk_bf16_f32 v85, v106, v107
    s_setprio 2
    v_mfma_f32_32x32x16_bf16 v[32:47], v[164:167], v[92:95], v[32:47]
    ds_read_b64_tr_b16 v[160:161], v138 offset:42752
    ds_read_b64_tr_b16 v[162:163], v139 offset:42752
    v_exp_f32 v108, v108
    v_exp_f32 v109, v109
    v_exp_f32 v110, v110
    v_exp_f32 v111, v111
    v_cvt_pk_bf16_f32 v86, v108, v109
    v_cvt_pk_bf16_f32 v87, v110, v111
    s_waitcnt lgkmcnt(2)
    v_mfma_f32_32x32x16_bf16 v[48:63], v[152:155], v[128:131], v[48:63]
    ds_read_b64_tr_b16 v[164:165], v140 offset:42752
    ds_read_b64_tr_b16 v[166:167], v141 offset:42752
    v_exp_f32 v112, v112
    v_exp_f32 v113, v113
    v_exp_f32 v114, v114
    v_exp_f32 v115, v115
    v_cvt_pk_bf16_f32 v88, v112, v113
    v_cvt_pk_bf16_f32 v89, v114, v115
    s_setprio 3
    v_mfma_f32_32x32x16_bf16 v[64:79], v[152:155], v[132:135], v[64:79]
    ds_read_b32 v156, v137 offset:58496
    v_exp_f32 v116, v116
    v_exp_f32 v117, v117
    v_exp_f32 v118, v118
    v_exp_f32 v119, v119
    v_cvt_pk_bf16_f32 v90, v116, v117
    v_cvt_pk_bf16_f32 v91, v118, v119
    s_waitcnt lgkmcnt(3)
    v_mfma_f32_32x32x16_bf16 v[16:31], v[160:163], v[80:83], v[16:31]
    v_exp_f32 v120, v120
    v_exp_f32 v121, v121
    v_exp_f32 v122, v122
    v_exp_f32 v123, v123
    v_cvt_pk_bf16_f32 v92, v120, v121
    v_cvt_pk_bf16_f32 v93, v122, v123
    s_setprio 0
    s_waitcnt lgkmcnt(1)
    v_mfma_f32_32x32x16_bf16 v[16:31], v[164:167], v[84:87], v[16:31]
    v_exp_f32 v124, v124
    v_exp_f32 v125, v125
    v_exp_f32 v126, v126
    v_exp_f32 v127, v127
    v_cvt_pk_bf16_f32 v94, v124, v125
    v_cvt_pk_bf16_f32 v95, v126, v127
    v_add_u32 v136, 58368, v136
    v_add_u32 v137, 58368, v137
    v_add_u32 v138, 58368, v138
    v_add_u32 v139, 58368, v139
    v_add_u32 v140, 58368, v140
    v_add_u32 v141, 58368, v141
    s_waitcnt lgkmcnt(0)
    v_mfma_f32_32x32x4_2b_bf16 v[96:127], v[156:157], v[150:151], 0
    ds_read_b128 v[152:155], v136 offset:1024
    v_exp_f32 v48, v48
    v_exp_f32 v49, v49
    v_exp_f32 v50, v50
    v_exp_f32 v51, v51
    v_cvt_pk_bf16_f32 v80, v48, v49
    v_cvt_pk_bf16_f32 v81, v50, v51
    s_setprio 1
    v_exp_f32 v52, v52
    v_exp_f32 v53, v53
    v_exp_f32 v54, v54
    v_exp_f32 v55, v55
    v_cvt_pk_bf16_f32 v82, v52, v53
    v_cvt_pk_bf16_f32 v83, v54, v55
    v_mfma_f32_32x32x16_bf16 v[32:47], v[160:163], v[88:91], v[32:47]
    v_exp_f32 v56, v56
    v_exp_f32 v57, v57
    v_exp_f32 v58, v58
    v_exp_f32 v59, v59
    v_cvt_pk_bf16_f32 v84, v56, v57
    v_cvt_pk_bf16_f32 v85, v58, v59
    s_setprio 2
    v_mfma_f32_32x32x16_bf16 v[32:47], v[164:167], v[92:95], v[32:47]
    ds_read_b64_tr_b16 v[160:161], v138 offset:0
    ds_read_b64_tr_b16 v[162:163], v139 offset:0
    v_exp_f32 v60, v60
    v_exp_f32 v61, v61
    v_exp_f32 v62, v62
    v_exp_f32 v63, v63
    v_cvt_pk_bf16_f32 v86, v60, v61
    v_cvt_pk_bf16_f32 v87, v62, v63
    s_waitcnt lgkmcnt(2)
    v_mfma_f32_32x32x16_bf16 v[96:111], v[152:155], v[128:131], v[96:111]
    ds_read_b64_tr_b16 v[164:165], v140 offset:0
    ds_read_b64_tr_b16 v[166:167], v141 offset:0
    v_exp_f32 v64, v64
    v_exp_f32 v65, v65
    v_exp_f32 v66, v66
    v_exp_f32 v67, v67
    v_cvt_pk_bf16_f32 v88, v64, v65
    v_cvt_pk_bf16_f32 v89, v66, v67
    s_setprio 3
    v_mfma_f32_32x32x16_bf16 v[112:127], v[152:155], v[132:135], v[112:127]
    ds_read_b32 v156, v137 offset:256
    v_exp_f32 v68, v68
    v_exp_f32 v69, v69
    v_exp_f32 v70, v70
    v_exp_f32 v71, v71
    v_cvt_pk_bf16_f32 v90, v68, v69
    v_cvt_pk_bf16_f32 v91, v70, v71
    s_waitcnt lgkmcnt(3)
    v_mfma_f32_32x32x16_bf16 v[16:31], v[160:163], v[80:83], v[16:31]
    v_exp_f32 v72, v72
    v_exp_f32 v73, v73
    v_exp_f32 v74, v74
    v_exp_f32 v75, v75
    v_cvt_pk_bf16_f32 v92, v72, v73
    v_cvt_pk_bf16_f32 v93, v74, v75
    s_setprio 0
    s_waitcnt lgkmcnt(1)
    v_mfma_f32_32x32x16_bf16 v[16:31], v[164:167], v[84:87], v[16:31]
    v_exp_f32 v76, v76
    v_exp_f32 v77, v77
    v_exp_f32 v78, v78
    v_exp_f32 v79, v79
    v_cvt_pk_bf16_f32 v94, v76, v77
    v_cvt_pk_bf16_f32 v95, v78, v79
    s_waitcnt lgkmcnt(0)
    v_mfma_f32_32x32x4_2b_bf16 v[48:79], v[156:157], v[150:151], 0
    ds_read_b128 v[152:155], v136 offset:2048
    v_exp_f32 v96, v96
    v_exp_f32 v97, v97
    v_exp_f32 v98, v98
    v_exp_f32 v99, v99
    v_cvt_pk_bf16_f32 v80, v96, v97
    v_cvt_pk_bf16_f32 v81, v98, v99
    s_setprio 1
    v_exp_f32 v100, v100
    v_exp_f32 v101, v101
    v_exp_f32 v102, v102
    v_exp_f32 v103, v103
    v_cvt_pk_bf16_f32 v82, v100, v101
    v_cvt_pk_bf16_f32 v83, v102, v103
    v_mfma_f32_32x32x16_bf16 v[32:47], v[160:163], v[88:91], v[32:47]
    v_exp_f32 v104, v104
    v_exp_f32 v105, v105
    v_exp_f32 v106, v106
    v_exp_f32 v107, v107
    v_cvt_pk_bf16_f32 v84, v104, v105
    v_cvt_pk_bf16_f32 v85, v106, v107
    s_setprio 2
    v_mfma_f32_32x32x16_bf16 v[32:47], v[164:167], v[92:95], v[32:47]
    ds_read_b64_tr_b16 v[160:161], v138 offset:1280
    ds_read_b64_tr_b16 v[162:163], v139 offset:1280
    v_exp_f32 v108, v108
    v_exp_f32 v109, v109
    v_exp_f32 v110, v110
    v_exp_f32 v111, v111
    v_cvt_pk_bf16_f32 v86, v108, v109
    v_cvt_pk_bf16_f32 v87, v110, v111
    s_waitcnt lgkmcnt(2)
    v_mfma_f32_32x32x16_bf16 v[48:63], v[152:155], v[128:131], v[48:63]
    ds_read_b64_tr_b16 v[164:165], v140 offset:1280
    ds_read_b64_tr_b16 v[166:167], v141 offset:1280
    v_exp_f32 v112, v112
    v_exp_f32 v113, v113
    v_exp_f32 v114, v114
    v_exp_f32 v115, v115
    v_cvt_pk_bf16_f32 v88, v112, v113
    v_cvt_pk_bf16_f32 v89, v114, v115
    s_setprio 3
    v_mfma_f32_32x32x16_bf16 v[64:79], v[152:155], v[132:135], v[64:79]
    ds_read_b32 v156, v137 offset:384
    v_exp_f32 v116, v116
    v_exp_f32 v117, v117
    v_exp_f32 v118, v118
    v_exp_f32 v119, v119
    v_cvt_pk_bf16_f32 v90, v116, v117
    v_cvt_pk_bf16_f32 v91, v118, v119
    s_waitcnt lgkmcnt(3)
    v_mfma_f32_32x32x16_bf16 v[16:31], v[160:163], v[80:83], v[16:31]
    v_exp_f32 v120, v120
    v_exp_f32 v121, v121
    v_exp_f32 v122, v122
    v_exp_f32 v123, v123
    v_cvt_pk_bf16_f32 v92, v120, v121
    v_cvt_pk_bf16_f32 v93, v122, v123
    s_setprio 0
    s_waitcnt lgkmcnt(1)
    v_mfma_f32_32x32x16_bf16 v[16:31], v[164:167], v[84:87], v[16:31]
    v_exp_f32 v124, v124
    v_exp_f32 v125, v125
    v_exp_f32 v126, v126
    v_exp_f32 v127, v127
    v_cvt_pk_bf16_f32 v94, v124, v125
    v_cvt_pk_bf16_f32 v95, v126, v127
    s_waitcnt lgkmcnt(0)
    v_mfma_f32_32x32x4_2b_bf16 v[96:127], v[156:157], v[150:151], 0
    ds_read_b128 v[152:155], v136 offset:3072
    v_exp_f32 v48, v48
    v_exp_f32 v49, v49
    v_exp_f32 v50, v50
    v_exp_f32 v51, v51
    v_cvt_pk_bf16_f32 v80, v48, v49
    v_cvt_pk_bf16_f32 v81, v50, v51
    s_setprio 1
    v_exp_f32 v52, v52
    v_exp_f32 v53, v53
    v_exp_f32 v54, v54
    v_exp_f32 v55, v55
    v_cvt_pk_bf16_f32 v82, v52, v53
    v_cvt_pk_bf16_f32 v83, v54, v55
    v_mfma_f32_32x32x16_bf16 v[32:47], v[160:163], v[88:91], v[32:47]
    v_exp_f32 v56, v56
    v_exp_f32 v57, v57
    v_exp_f32 v58, v58
    v_exp_f32 v59, v59
    v_cvt_pk_bf16_f32 v84, v56, v57
    v_cvt_pk_bf16_f32 v85, v58, v59
    s_setprio 2
    v_mfma_f32_32x32x16_bf16 v[32:47], v[164:167], v[92:95], v[32:47]
    ds_read_b64_tr_b16 v[160:161], v138 offset:2560
    ds_read_b64_tr_b16 v[162:163], v139 offset:2560
    v_exp_f32 v60, v60
    v_exp_f32 v61, v61
    v_exp_f32 v62, v62
    v_exp_f32 v63, v63
    v_cvt_pk_bf16_f32 v86, v60, v61
    v_cvt_pk_bf16_f32 v87, v62, v63
    s_waitcnt lgkmcnt(2)
    v_mfma_f32_32x32x16_bf16 v[96:111], v[152:155], v[128:131], v[96:111]
    ds_read_b64_tr_b16 v[164:165], v140 offset:2560
    ds_read_b64_tr_b16 v[166:167], v141 offset:2560
    v_exp_f32 v64, v64
    v_exp_f32 v65, v65
    v_exp_f32 v66, v66
    v_exp_f32 v67, v67
    v_cvt_pk_bf16_f32 v88, v64, v65
    v_cvt_pk_bf16_f32 v89, v66, v67
    s_setprio 3
    v_mfma_f32_32x32x16_bf16 v[112:127], v[152:155], v[132:135], v[112:127]
    v_exp_f32 v68, v68
    v_exp_f32 v69, v69
    v_exp_f32 v70, v70
    v_exp_f32 v71, v71
    v_cvt_pk_bf16_f32 v90, v68, v69
    v_cvt_pk_bf16_f32 v91, v70, v71
    s_waitcnt lgkmcnt(2)
    v_mfma_f32_32x32x16_bf16 v[16:31], v[160:163], v[80:83], v[16:31]
    v_exp_f32 v72, v72
    v_exp_f32 v73, v73
    v_exp_f32 v74, v74
    v_exp_f32 v75, v75
    v_cvt_pk_bf16_f32 v92, v72, v73
    v_cvt_pk_bf16_f32 v93, v74, v75
    s_setprio 0
    s_waitcnt lgkmcnt(0)
    v_mfma_f32_32x32x16_bf16 v[16:31], v[164:167], v[84:87], v[16:31]
    v_exp_f32 v76, v76
    v_exp_f32 v77, v77
    v_exp_f32 v78, v78
    v_exp_f32 v79, v79
    v_cvt_pk_bf16_f32 v94, v76, v77
    v_cvt_pk_bf16_f32 v95, v78, v79
    s_waitcnt vmcnt(0)
    s_barrier
    ds_read_b32 v156, v137 offset:19456
    ds_read_b128 v[152:155], v136 offset:19456
    v_exp_f32 v96, v96
    v_exp_f32 v97, v97
    v_exp_f32 v98, v98
    v_exp_f32 v99, v99
    v_cvt_pk_bf16_f32 v80, v96, v97
    v_cvt_pk_bf16_f32 v81, v98, v99
    s_setprio 1
    s_waitcnt lgkmcnt(1)
    v_mfma_f32_32x32x4_2b_bf16 v[48:79], v[156:157], v[150:151], 0
    v_exp_f32 v100, v100
    v_exp_f32 v101, v101
    v_exp_f32 v102, v102
    v_exp_f32 v103, v103
    v_cvt_pk_bf16_f32 v82, v100, v101
    v_cvt_pk_bf16_f32 v83, v102, v103
    v_mfma_f32_32x32x16_bf16 v[32:47], v[160:163], v[88:91], v[32:47]
    v_exp_f32 v104, v104
    v_exp_f32 v105, v105
    v_exp_f32 v106, v106
    v_exp_f32 v107, v107
    v_cvt_pk_bf16_f32 v84, v104, v105
    v_cvt_pk_bf16_f32 v85, v106, v107
    s_setprio 2
    v_mfma_f32_32x32x16_bf16 v[32:47], v[164:167], v[92:95], v[32:47]
    ds_read_b64_tr_b16 v[160:161], v138 offset:3840
    ds_read_b64_tr_b16 v[162:163], v139 offset:3840
    v_exp_f32 v108, v108
    v_exp_f32 v109, v109
    v_exp_f32 v110, v110
    v_exp_f32 v111, v111
    v_cvt_pk_bf16_f32 v86, v108, v109
    v_cvt_pk_bf16_f32 v87, v110, v111
    s_waitcnt lgkmcnt(2)
    v_mfma_f32_32x32x16_bf16 v[48:63], v[152:155], v[128:131], v[48:63]
    ds_read_b64_tr_b16 v[164:165], v140 offset:3840
    ds_read_b64_tr_b16 v[166:167], v141 offset:3840
    v_exp_f32 v112, v112
    v_exp_f32 v113, v113
    v_exp_f32 v114, v114
    v_exp_f32 v115, v115
    v_cvt_pk_bf16_f32 v88, v112, v113
    v_cvt_pk_bf16_f32 v89, v114, v115
    s_setprio 3
    v_mfma_f32_32x32x16_bf16 v[64:79], v[152:155], v[132:135], v[64:79]
    ds_read_b32 v156, v137 offset:19584
    v_exp_f32 v116, v116
    v_exp_f32 v117, v117
    v_exp_f32 v118, v118
    v_exp_f32 v119, v119
    v_cvt_pk_bf16_f32 v90, v116, v117
    v_cvt_pk_bf16_f32 v91, v118, v119
    s_waitcnt lgkmcnt(3)
    v_mfma_f32_32x32x16_bf16 v[16:31], v[160:163], v[80:83], v[16:31]
    v_exp_f32 v120, v120
    v_exp_f32 v121, v121
    v_exp_f32 v122, v122
    v_exp_f32 v123, v123
    v_cvt_pk_bf16_f32 v92, v120, v121
    v_cvt_pk_bf16_f32 v93, v122, v123
    s_setprio 0
    s_waitcnt lgkmcnt(1)
    v_mfma_f32_32x32x16_bf16 v[16:31], v[164:167], v[84:87], v[16:31]
    v_exp_f32 v124, v124
    v_exp_f32 v125, v125
    v_exp_f32 v126, v126
    v_exp_f32 v127, v127
    v_cvt_pk_bf16_f32 v94, v124, v125
    v_cvt_pk_bf16_f32 v95, v126, v127
    s_waitcnt lgkmcnt(0)
    v_mfma_f32_32x32x4_2b_bf16 v[96:127], v[156:157], v[150:151], 0
    ds_read_b128 v[152:155], v136 offset:20480
    v_exp_f32 v48, v48
    v_exp_f32 v49, v49
    v_exp_f32 v50, v50
    v_exp_f32 v51, v51
    v_cvt_pk_bf16_f32 v80, v48, v49
    v_cvt_pk_bf16_f32 v81, v50, v51
    s_setprio 1
    v_exp_f32 v52, v52
    v_exp_f32 v53, v53
    v_exp_f32 v54, v54
    v_exp_f32 v55, v55
    v_cvt_pk_bf16_f32 v82, v52, v53
    v_cvt_pk_bf16_f32 v83, v54, v55
    v_mfma_f32_32x32x16_bf16 v[32:47], v[160:163], v[88:91], v[32:47]
    v_exp_f32 v56, v56
    v_exp_f32 v57, v57
    v_exp_f32 v58, v58
    v_exp_f32 v59, v59
    v_cvt_pk_bf16_f32 v84, v56, v57
    v_cvt_pk_bf16_f32 v85, v58, v59
    s_setprio 2
    v_mfma_f32_32x32x16_bf16 v[32:47], v[164:167], v[92:95], v[32:47]
    ds_read_b64_tr_b16 v[160:161], v138 offset:19456
    ds_read_b64_tr_b16 v[162:163], v139 offset:19456
    v_exp_f32 v60, v60
    v_exp_f32 v61, v61
    v_exp_f32 v62, v62
    v_exp_f32 v63, v63
    v_cvt_pk_bf16_f32 v86, v60, v61
    v_cvt_pk_bf16_f32 v87, v62, v63
    s_waitcnt lgkmcnt(2)
    v_mfma_f32_32x32x16_bf16 v[96:111], v[152:155], v[128:131], v[96:111]
    ds_read_b64_tr_b16 v[164:165], v140 offset:19456
    ds_read_b64_tr_b16 v[166:167], v141 offset:19456
    v_exp_f32 v64, v64
    v_exp_f32 v65, v65
    v_exp_f32 v66, v66
    v_exp_f32 v67, v67
    v_cvt_pk_bf16_f32 v88, v64, v65
    v_cvt_pk_bf16_f32 v89, v66, v67
    s_setprio 3
    v_mfma_f32_32x32x16_bf16 v[112:127], v[152:155], v[132:135], v[112:127]
    ds_read_b32 v156, v137 offset:19712
    v_exp_f32 v68, v68
    v_exp_f32 v69, v69
    v_exp_f32 v70, v70
    v_exp_f32 v71, v71
    v_cvt_pk_bf16_f32 v90, v68, v69
    v_cvt_pk_bf16_f32 v91, v70, v71
    s_waitcnt lgkmcnt(3)
    v_mfma_f32_32x32x16_bf16 v[16:31], v[160:163], v[80:83], v[16:31]
    v_exp_f32 v72, v72
    v_exp_f32 v73, v73
    v_exp_f32 v74, v74
    v_exp_f32 v75, v75
    v_cvt_pk_bf16_f32 v92, v72, v73
    v_cvt_pk_bf16_f32 v93, v74, v75
    s_setprio 0
    s_waitcnt lgkmcnt(1)
    v_mfma_f32_32x32x16_bf16 v[16:31], v[164:167], v[84:87], v[16:31]
    v_exp_f32 v76, v76
    v_exp_f32 v77, v77
    v_exp_f32 v78, v78
    v_exp_f32 v79, v79
    v_cvt_pk_bf16_f32 v94, v76, v77
    v_cvt_pk_bf16_f32 v95, v78, v79
    s_waitcnt lgkmcnt(0)
    v_mfma_f32_32x32x4_2b_bf16 v[48:79], v[156:157], v[150:151], 0
    ds_read_b128 v[152:155], v136 offset:21504
    v_exp_f32 v96, v96
    v_exp_f32 v97, v97
    v_exp_f32 v98, v98
    v_exp_f32 v99, v99
    v_cvt_pk_bf16_f32 v80, v96, v97
    v_cvt_pk_bf16_f32 v81, v98, v99
    s_setprio 1
    v_exp_f32 v100, v100
    v_exp_f32 v101, v101
    v_exp_f32 v102, v102
    v_exp_f32 v103, v103
    v_cvt_pk_bf16_f32 v82, v100, v101
    v_cvt_pk_bf16_f32 v83, v102, v103
    v_mfma_f32_32x32x16_bf16 v[32:47], v[160:163], v[88:91], v[32:47]
    v_exp_f32 v104, v104
    v_exp_f32 v105, v105
    v_exp_f32 v106, v106
    v_exp_f32 v107, v107
    v_cvt_pk_bf16_f32 v84, v104, v105
    v_cvt_pk_bf16_f32 v85, v106, v107
    s_setprio 2
    v_mfma_f32_32x32x16_bf16 v[32:47], v[164:167], v[92:95], v[32:47]
    ds_read_b64_tr_b16 v[160:161], v138 offset:20736
    ds_read_b64_tr_b16 v[162:163], v139 offset:20736
    v_exp_f32 v108, v108
    v_exp_f32 v109, v109
    v_exp_f32 v110, v110
    v_exp_f32 v111, v111
    v_cvt_pk_bf16_f32 v86, v108, v109
    v_cvt_pk_bf16_f32 v87, v110, v111
    s_waitcnt lgkmcnt(2)
    v_mfma_f32_32x32x16_bf16 v[48:63], v[152:155], v[128:131], v[48:63]
    ds_read_b64_tr_b16 v[164:165], v140 offset:20736
    ds_read_b64_tr_b16 v[166:167], v141 offset:20736
    v_exp_f32 v112, v112
    v_exp_f32 v113, v113
    v_exp_f32 v114, v114
    v_exp_f32 v115, v115
    v_cvt_pk_bf16_f32 v88, v112, v113
    v_cvt_pk_bf16_f32 v89, v114, v115
    s_setprio 3
    v_mfma_f32_32x32x16_bf16 v[64:79], v[152:155], v[132:135], v[64:79]
    ds_read_b32 v156, v137 offset:19840
    v_exp_f32 v116, v116
    v_exp_f32 v117, v117
    v_exp_f32 v118, v118
    v_exp_f32 v119, v119
    v_cvt_pk_bf16_f32 v90, v116, v117
    v_cvt_pk_bf16_f32 v91, v118, v119
    s_waitcnt lgkmcnt(3)
    v_mfma_f32_32x32x16_bf16 v[16:31], v[160:163], v[80:83], v[16:31]
    v_exp_f32 v120, v120
    v_exp_f32 v121, v121
    v_exp_f32 v122, v122
    v_exp_f32 v123, v123
    v_cvt_pk_bf16_f32 v92, v120, v121
    v_cvt_pk_bf16_f32 v93, v122, v123
    s_setprio 0
    s_waitcnt lgkmcnt(1)
    v_mfma_f32_32x32x16_bf16 v[16:31], v[164:167], v[84:87], v[16:31]
    v_exp_f32 v124, v124
    v_exp_f32 v125, v125
    v_exp_f32 v126, v126
    v_exp_f32 v127, v127
    v_cvt_pk_bf16_f32 v94, v124, v125
    v_cvt_pk_bf16_f32 v95, v126, v127
    s_waitcnt lgkmcnt(0)
    v_mfma_f32_32x32x4_2b_bf16 v[96:127], v[156:157], v[150:151], 0
    ds_read_b128 v[152:155], v136 offset:22528
    v_exp_f32 v48, v48
    v_exp_f32 v49, v49
    v_exp_f32 v50, v50
    v_exp_f32 v51, v51
    v_cvt_pk_bf16_f32 v80, v48, v49
    v_cvt_pk_bf16_f32 v81, v50, v51
    s_setprio 1
    v_exp_f32 v52, v52
    v_exp_f32 v53, v53
    v_exp_f32 v54, v54
    v_exp_f32 v55, v55
    v_cvt_pk_bf16_f32 v82, v52, v53
    v_cvt_pk_bf16_f32 v83, v54, v55
    v_mfma_f32_32x32x16_bf16 v[32:47], v[160:163], v[88:91], v[32:47]
    v_exp_f32 v56, v56
    v_exp_f32 v57, v57
    v_exp_f32 v58, v58
    v_exp_f32 v59, v59
    v_cvt_pk_bf16_f32 v84, v56, v57
    v_cvt_pk_bf16_f32 v85, v58, v59
    s_setprio 2
    v_mfma_f32_32x32x16_bf16 v[32:47], v[164:167], v[92:95], v[32:47]
    ds_read_b64_tr_b16 v[160:161], v138 offset:22016
    ds_read_b64_tr_b16 v[162:163], v139 offset:22016
    v_exp_f32 v60, v60
    v_exp_f32 v61, v61
    v_exp_f32 v62, v62
    v_exp_f32 v63, v63
    v_cvt_pk_bf16_f32 v86, v60, v61
    v_cvt_pk_bf16_f32 v87, v62, v63
    s_waitcnt lgkmcnt(2)
    v_mfma_f32_32x32x16_bf16 v[96:111], v[152:155], v[128:131], v[96:111]
    ds_read_b64_tr_b16 v[164:165], v140 offset:22016
    ds_read_b64_tr_b16 v[166:167], v141 offset:22016
    v_exp_f32 v64, v64
    v_exp_f32 v65, v65
    v_exp_f32 v66, v66
    v_exp_f32 v67, v67
    v_cvt_pk_bf16_f32 v88, v64, v65
    v_cvt_pk_bf16_f32 v89, v66, v67
    s_setprio 3
    v_mfma_f32_32x32x16_bf16 v[112:127], v[152:155], v[132:135], v[112:127]
    ds_read_b32 v156, v137 offset:38912
    v_exp_f32 v68, v68
    v_exp_f32 v69, v69
    v_exp_f32 v70, v70
    v_exp_f32 v71, v71
    v_cvt_pk_bf16_f32 v90, v68, v69
    v_cvt_pk_bf16_f32 v91, v70, v71
    s_waitcnt lgkmcnt(3)
    v_mfma_f32_32x32x16_bf16 v[16:31], v[160:163], v[80:83], v[16:31]
    v_exp_f32 v72, v72
    v_exp_f32 v73, v73
    v_exp_f32 v74, v74
    v_exp_f32 v75, v75
    v_cvt_pk_bf16_f32 v92, v72, v73
    v_cvt_pk_bf16_f32 v93, v74, v75
    s_setprio 0
    s_waitcnt lgkmcnt(1)
    v_mfma_f32_32x32x16_bf16 v[16:31], v[164:167], v[84:87], v[16:31]
    v_exp_f32 v76, v76
    v_exp_f32 v77, v77
    v_exp_f32 v78, v78
    v_exp_f32 v79, v79
    v_cvt_pk_bf16_f32 v94, v76, v77
    v_cvt_pk_bf16_f32 v95, v78, v79
    s_waitcnt lgkmcnt(0)
    v_mfma_f32_32x32x4_2b_bf16 v[48:79], v[156:157], v[150:151], 0
    ds_read_b128 v[152:155], v136 offset:38912
    v_exp_f32 v96, v96
    v_exp_f32 v97, v97
    v_exp_f32 v98, v98
    v_exp_f32 v99, v99
    v_cvt_pk_bf16_f32 v80, v96, v97
    v_cvt_pk_bf16_f32 v81, v98, v99
    s_setprio 1
    v_exp_f32 v100, v100
    v_exp_f32 v101, v101
    v_exp_f32 v102, v102
    v_exp_f32 v103, v103
    v_cvt_pk_bf16_f32 v82, v100, v101
    v_cvt_pk_bf16_f32 v83, v102, v103
    v_mfma_f32_32x32x16_bf16 v[32:47], v[160:163], v[88:91], v[32:47]
    v_exp_f32 v104, v104
    v_exp_f32 v105, v105
    v_exp_f32 v106, v106
    v_exp_f32 v107, v107
    v_cvt_pk_bf16_f32 v84, v104, v105
    v_cvt_pk_bf16_f32 v85, v106, v107
    s_setprio 2
    v_mfma_f32_32x32x16_bf16 v[32:47], v[164:167], v[92:95], v[32:47]
    ds_read_b64_tr_b16 v[160:161], v138 offset:23296
    ds_read_b64_tr_b16 v[162:163], v139 offset:23296
    v_exp_f32 v108, v108
    v_exp_f32 v109, v109
    v_exp_f32 v110, v110
    v_exp_f32 v111, v111
    v_cvt_pk_bf16_f32 v86, v108, v109
    v_cvt_pk_bf16_f32 v87, v110, v111
    s_waitcnt lgkmcnt(2)
    v_mfma_f32_32x32x16_bf16 v[48:63], v[152:155], v[128:131], v[48:63]
    ds_read_b64_tr_b16 v[164:165], v140 offset:23296
    ds_read_b64_tr_b16 v[166:167], v141 offset:23296
    v_exp_f32 v112, v112
    v_exp_f32 v113, v113
    v_exp_f32 v114, v114
    v_exp_f32 v115, v115
    v_cvt_pk_bf16_f32 v88, v112, v113
    v_cvt_pk_bf16_f32 v89, v114, v115
    s_setprio 3
    v_mfma_f32_32x32x16_bf16 v[64:79], v[152:155], v[132:135], v[64:79]
    ds_read_b32 v156, v137 offset:39040
    v_exp_f32 v116, v116
    v_exp_f32 v117, v117
    v_exp_f32 v118, v118
    v_exp_f32 v119, v119
    v_cvt_pk_bf16_f32 v90, v116, v117
    v_cvt_pk_bf16_f32 v91, v118, v119
    s_waitcnt lgkmcnt(3)
    v_mfma_f32_32x32x16_bf16 v[16:31], v[160:163], v[80:83], v[16:31]
    v_exp_f32 v120, v120
    v_exp_f32 v121, v121
    v_exp_f32 v122, v122
    v_exp_f32 v123, v123
    v_cvt_pk_bf16_f32 v92, v120, v121
    v_cvt_pk_bf16_f32 v93, v122, v123
    s_setprio 0
    s_waitcnt lgkmcnt(1)
    v_mfma_f32_32x32x16_bf16 v[16:31], v[164:167], v[84:87], v[16:31]
    v_exp_f32 v124, v124
    v_exp_f32 v125, v125
    v_exp_f32 v126, v126
    v_exp_f32 v127, v127
    v_cvt_pk_bf16_f32 v94, v124, v125
    v_cvt_pk_bf16_f32 v95, v126, v127
    s_waitcnt lgkmcnt(0)
    v_mfma_f32_32x32x4_2b_bf16 v[96:127], v[156:157], v[150:151], 0
    ds_read_b128 v[152:155], v136 offset:39936
    v_exp_f32 v48, v48
    v_exp_f32 v49, v49
    v_exp_f32 v50, v50
    v_exp_f32 v51, v51
    v_cvt_pk_bf16_f32 v80, v48, v49
    v_cvt_pk_bf16_f32 v81, v50, v51
    s_setprio 1
    v_exp_f32 v52, v52
    v_exp_f32 v53, v53
    v_exp_f32 v54, v54
    v_exp_f32 v55, v55
    v_cvt_pk_bf16_f32 v82, v52, v53
    v_cvt_pk_bf16_f32 v83, v54, v55
    v_mfma_f32_32x32x16_bf16 v[32:47], v[160:163], v[88:91], v[32:47]
    v_exp_f32 v56, v56
    v_exp_f32 v57, v57
    v_exp_f32 v58, v58
    v_exp_f32 v59, v59
    v_cvt_pk_bf16_f32 v84, v56, v57
    v_cvt_pk_bf16_f32 v85, v58, v59
    s_setprio 2
    v_mfma_f32_32x32x16_bf16 v[32:47], v[164:167], v[92:95], v[32:47]
    ds_read_b64_tr_b16 v[160:161], v138 offset:38912
    ds_read_b64_tr_b16 v[162:163], v139 offset:38912
    v_exp_f32 v60, v60
    v_exp_f32 v61, v61
    v_exp_f32 v62, v62
    v_exp_f32 v63, v63
    v_cvt_pk_bf16_f32 v86, v60, v61
    v_cvt_pk_bf16_f32 v87, v62, v63
    s_waitcnt lgkmcnt(2)
    v_mfma_f32_32x32x16_bf16 v[96:111], v[152:155], v[128:131], v[96:111]
    ds_read_b64_tr_b16 v[164:165], v140 offset:38912
    ds_read_b64_tr_b16 v[166:167], v141 offset:38912
    v_exp_f32 v64, v64
    v_exp_f32 v65, v65
    v_exp_f32 v66, v66
    v_exp_f32 v67, v67
    v_cvt_pk_bf16_f32 v88, v64, v65
    v_cvt_pk_bf16_f32 v89, v66, v67
    s_setprio 3
    v_mfma_f32_32x32x16_bf16 v[112:127], v[152:155], v[132:135], v[112:127]
    ds_read_b32 v156, v137 offset:39168
    v_exp_f32 v68, v68
    v_exp_f32 v69, v69
    v_exp_f32 v70, v70
    v_exp_f32 v71, v71
    v_cvt_pk_bf16_f32 v90, v68, v69
    v_cvt_pk_bf16_f32 v91, v70, v71
    s_waitcnt lgkmcnt(3)
    v_mfma_f32_32x32x16_bf16 v[16:31], v[160:163], v[80:83], v[16:31]
    v_exp_f32 v72, v72
    v_exp_f32 v73, v73
    v_exp_f32 v74, v74
    v_exp_f32 v75, v75
    v_cvt_pk_bf16_f32 v92, v72, v73
    v_cvt_pk_bf16_f32 v93, v74, v75
    s_setprio 0
    s_waitcnt lgkmcnt(1)
    v_mfma_f32_32x32x16_bf16 v[16:31], v[164:167], v[84:87], v[16:31]
    v_exp_f32 v76, v76
    v_exp_f32 v77, v77
    v_exp_f32 v78, v78
    v_exp_f32 v79, v79
    v_cvt_pk_bf16_f32 v94, v76, v77
    v_cvt_pk_bf16_f32 v95, v78, v79
    s_waitcnt lgkmcnt(0)
    v_mfma_f32_32x32x4_2b_bf16 v[48:79], v[156:157], v[150:151], 0
    ds_read_b128 v[152:155], v136 offset:40960
    v_exp_f32 v96, v96
    v_exp_f32 v97, v97
    v_exp_f32 v98, v98
    v_exp_f32 v99, v99
    v_cvt_pk_bf16_f32 v80, v96, v97
    v_cvt_pk_bf16_f32 v81, v98, v99
    s_setprio 1
    v_exp_f32 v100, v100
    v_exp_f32 v101, v101
    v_exp_f32 v102, v102
    v_exp_f32 v103, v103
    v_cvt_pk_bf16_f32 v82, v100, v101
    v_cvt_pk_bf16_f32 v83, v102, v103
    v_mfma_f32_32x32x16_bf16 v[32:47], v[160:163], v[88:91], v[32:47]
    v_exp_f32 v104, v104
    v_exp_f32 v105, v105
    v_exp_f32 v106, v106
    v_exp_f32 v107, v107
    v_cvt_pk_bf16_f32 v84, v104, v105
    v_cvt_pk_bf16_f32 v85, v106, v107
    s_setprio 2
    v_mfma_f32_32x32x16_bf16 v[32:47], v[164:167], v[92:95], v[32:47]
    ds_read_b64_tr_b16 v[160:161], v138 offset:40192
    ds_read_b64_tr_b16 v[162:163], v139 offset:40192
    v_exp_f32 v108, v108
    v_exp_f32 v109, v109
    v_exp_f32 v110, v110
    v_exp_f32 v111, v111
    v_cvt_pk_bf16_f32 v86, v108, v109
    v_cvt_pk_bf16_f32 v87, v110, v111
    s_waitcnt lgkmcnt(2)
    v_mfma_f32_32x32x16_bf16 v[48:63], v[152:155], v[128:131], v[48:63]
    ds_read_b64_tr_b16 v[164:165], v140 offset:40192
    ds_read_b64_tr_b16 v[166:167], v141 offset:40192
    v_exp_f32 v112, v112
    v_exp_f32 v113, v113
    v_exp_f32 v114, v114
    v_exp_f32 v115, v115
    v_cvt_pk_bf16_f32 v88, v112, v113
    v_cvt_pk_bf16_f32 v89, v114, v115
    s_setprio 3
    v_mfma_f32_32x32x16_bf16 v[64:79], v[152:155], v[132:135], v[64:79]
    ds_read_b32 v156, v137 offset:39296
    v_exp_f32 v116, v116
    v_exp_f32 v117, v117
    v_exp_f32 v118, v118
    v_exp_f32 v119, v119
    v_cvt_pk_bf16_f32 v90, v116, v117
    v_cvt_pk_bf16_f32 v91, v118, v119
    s_waitcnt lgkmcnt(3)
    v_mfma_f32_32x32x16_bf16 v[16:31], v[160:163], v[80:83], v[16:31]
    v_exp_f32 v120, v120
    v_exp_f32 v121, v121
    v_exp_f32 v122, v122
    v_exp_f32 v123, v123
    v_cvt_pk_bf16_f32 v92, v120, v121
    v_cvt_pk_bf16_f32 v93, v122, v123
    s_setprio 0
    s_waitcnt lgkmcnt(1)
    v_mfma_f32_32x32x16_bf16 v[16:31], v[164:167], v[84:87], v[16:31]
    v_exp_f32 v124, v124
    v_exp_f32 v125, v125
    v_exp_f32 v126, v126
    v_exp_f32 v127, v127
    v_cvt_pk_bf16_f32 v94, v124, v125
    v_cvt_pk_bf16_f32 v95, v126, v127
    s_waitcnt lgkmcnt(0)
    v_mfma_f32_32x32x4_2b_bf16 v[96:127], v[156:157], v[150:151], 0
    ds_read_b128 v[152:155], v136 offset:41984
    v_exp_f32 v48, v48
    v_exp_f32 v49, v49
    v_exp_f32 v50, v50
    v_exp_f32 v51, v51
    v_cvt_pk_bf16_f32 v80, v48, v49
    v_cvt_pk_bf16_f32 v81, v50, v51
    s_setprio 1
    v_exp_f32 v52, v52
    v_exp_f32 v53, v53
    v_exp_f32 v54, v54
    v_exp_f32 v55, v55
    v_cvt_pk_bf16_f32 v82, v52, v53
    v_cvt_pk_bf16_f32 v83, v54, v55
    v_mfma_f32_32x32x16_bf16 v[32:47], v[160:163], v[88:91], v[32:47]
    v_exp_f32 v56, v56
    v_exp_f32 v57, v57
    v_exp_f32 v58, v58
    v_exp_f32 v59, v59
    v_cvt_pk_bf16_f32 v84, v56, v57
    v_cvt_pk_bf16_f32 v85, v58, v59
    s_setprio 2
    v_mfma_f32_32x32x16_bf16 v[32:47], v[164:167], v[92:95], v[32:47]
    ds_read_b64_tr_b16 v[160:161], v138 offset:41472
    ds_read_b64_tr_b16 v[162:163], v139 offset:41472
    v_exp_f32 v60, v60
    v_exp_f32 v61, v61
    v_exp_f32 v62, v62
    v_exp_f32 v63, v63
    v_cvt_pk_bf16_f32 v86, v60, v61
    v_cvt_pk_bf16_f32 v87, v62, v63
    s_waitcnt lgkmcnt(2)
    v_mfma_f32_32x32x16_bf16 v[96:111], v[152:155], v[128:131], v[96:111]
    ds_read_b64_tr_b16 v[164:165], v140 offset:41472
    ds_read_b64_tr_b16 v[166:167], v141 offset:41472
    v_exp_f32 v64, v64
    v_exp_f32 v65, v65
    v_exp_f32 v66, v66
    v_exp_f32 v67, v67
    v_cvt_pk_bf16_f32 v88, v64, v65
    v_cvt_pk_bf16_f32 v89, v66, v67
    s_setprio 3
    v_mfma_f32_32x32x16_bf16 v[112:127], v[152:155], v[132:135], v[112:127]
    ds_read_b32 v156, v137 offset:58368
    v_exp_f32 v68, v68
    v_exp_f32 v69, v69
    v_exp_f32 v70, v70
    v_exp_f32 v71, v71
    v_cvt_pk_bf16_f32 v90, v68, v69
    v_cvt_pk_bf16_f32 v91, v70, v71
    s_waitcnt lgkmcnt(3)
    v_mfma_f32_32x32x16_bf16 v[16:31], v[160:163], v[80:83], v[16:31]
    v_exp_f32 v72, v72
    v_exp_f32 v73, v73
    v_exp_f32 v74, v74
    v_exp_f32 v75, v75
    v_cvt_pk_bf16_f32 v92, v72, v73
    v_cvt_pk_bf16_f32 v93, v74, v75
    s_setprio 0
    s_waitcnt lgkmcnt(1)
    v_mfma_f32_32x32x16_bf16 v[16:31], v[164:167], v[84:87], v[16:31]
    v_exp_f32 v76, v76
    v_exp_f32 v77, v77
    v_exp_f32 v78, v78
    v_exp_f32 v79, v79
    v_cvt_pk_bf16_f32 v94, v76, v77
    v_cvt_pk_bf16_f32 v95, v78, v79
    s_waitcnt lgkmcnt(0)
    v_mfma_f32_32x32x4_2b_bf16 v[48:79], v[156:157], v[150:151], 0
    ds_read_b128 v[152:155], v136 offset:58368
    v_exp_f32 v96, v96
    v_exp_f32 v97, v97
    v_exp_f32 v98, v98
    v_exp_f32 v99, v99
    v_cvt_pk_bf16_f32 v80, v96, v97
    v_cvt_pk_bf16_f32 v81, v98, v99
    s_setprio 1
    v_exp_f32 v100, v100
    v_exp_f32 v101, v101
    v_exp_f32 v102, v102
    v_exp_f32 v103, v103
    v_cvt_pk_bf16_f32 v82, v100, v101
    v_cvt_pk_bf16_f32 v83, v102, v103
    v_mfma_f32_32x32x16_bf16 v[32:47], v[160:163], v[88:91], v[32:47]
    v_exp_f32 v104, v104
    v_exp_f32 v105, v105
    v_exp_f32 v106, v106
    v_exp_f32 v107, v107
    v_cvt_pk_bf16_f32 v84, v104, v105
    v_cvt_pk_bf16_f32 v85, v106, v107
    s_setprio 2
    v_mfma_f32_32x32x16_bf16 v[32:47], v[164:167], v[92:95], v[32:47]
    ds_read_b64_tr_b16 v[160:161], v138 offset:42752
    ds_read_b64_tr_b16 v[162:163], v139 offset:42752
    v_exp_f32 v108, v108
    v_exp_f32 v109, v109
    v_exp_f32 v110, v110
    v_exp_f32 v111, v111
    v_cvt_pk_bf16_f32 v86, v108, v109
    v_cvt_pk_bf16_f32 v87, v110, v111
    s_waitcnt lgkmcnt(2)
    v_mfma_f32_32x32x16_bf16 v[48:63], v[152:155], v[128:131], v[48:63]
    ds_read_b64_tr_b16 v[164:165], v140 offset:42752
    ds_read_b64_tr_b16 v[166:167], v141 offset:42752
    v_exp_f32 v112, v112
    v_exp_f32 v113, v113
    v_exp_f32 v114, v114
    v_exp_f32 v115, v115
    v_cvt_pk_bf16_f32 v88, v112, v113
    v_cvt_pk_bf16_f32 v89, v114, v115
    s_setprio 3
    v_mfma_f32_32x32x16_bf16 v[64:79], v[152:155], v[132:135], v[64:79]
    ds_read_b32 v156, v137 offset:58496
    v_exp_f32 v116, v116
    v_exp_f32 v117, v117
    v_exp_f32 v118, v118
    v_exp_f32 v119, v119
    v_cvt_pk_bf16_f32 v90, v116, v117
    v_cvt_pk_bf16_f32 v91, v118, v119
    s_waitcnt lgkmcnt(3)
    v_mfma_f32_32x32x16_bf16 v[16:31], v[160:163], v[80:83], v[16:31]
    v_exp_f32 v120, v120
    v_exp_f32 v121, v121
    v_exp_f32 v122, v122
    v_exp_f32 v123, v123
    v_cvt_pk_bf16_f32 v92, v120, v121
    v_cvt_pk_bf16_f32 v93, v122, v123
    s_setprio 0
    s_waitcnt lgkmcnt(1)
    v_mfma_f32_32x32x16_bf16 v[16:31], v[164:167], v[84:87], v[16:31]
    v_exp_f32 v124, v124
    v_exp_f32 v125, v125
    v_exp_f32 v126, v126
    v_exp_f32 v127, v127
    v_cvt_pk_bf16_f32 v94, v124, v125
    v_cvt_pk_bf16_f32 v95, v126, v127
    v_add_u32 v136, 58368, v136
    v_add_u32 v137, 58368, v137
    v_add_u32 v138, 58368, v138
    v_add_u32 v139, 58368, v139
    v_add_u32 v140, 58368, v140
    v_add_u32 v141, 58368, v141
    s_waitcnt lgkmcnt(0)
    v_mfma_f32_32x32x4_2b_bf16 v[96:127], v[156:157], v[150:151], 0
    ds_read_b128 v[152:155], v136 offset:1024
    v_exp_f32 v48, v48
    v_exp_f32 v49, v49
    v_exp_f32 v50, v50
    v_exp_f32 v51, v51
    v_cvt_pk_bf16_f32 v80, v48, v49
    v_cvt_pk_bf16_f32 v81, v50, v51
    s_setprio 1
    v_exp_f32 v52, v52
    v_exp_f32 v53, v53
    v_exp_f32 v54, v54
    v_exp_f32 v55, v55
    v_cvt_pk_bf16_f32 v82, v52, v53
    v_cvt_pk_bf16_f32 v83, v54, v55
    v_mfma_f32_32x32x16_bf16 v[32:47], v[160:163], v[88:91], v[32:47]
    v_exp_f32 v56, v56
    v_exp_f32 v57, v57
    v_exp_f32 v58, v58
    v_exp_f32 v59, v59
    v_cvt_pk_bf16_f32 v84, v56, v57
    v_cvt_pk_bf16_f32 v85, v58, v59
    s_setprio 2
    v_mfma_f32_32x32x16_bf16 v[32:47], v[164:167], v[92:95], v[32:47]
    ds_read_b64_tr_b16 v[160:161], v138 offset:0
    ds_read_b64_tr_b16 v[162:163], v139 offset:0
    v_exp_f32 v60, v60
    v_exp_f32 v61, v61
    v_exp_f32 v62, v62
    v_exp_f32 v63, v63
    v_cvt_pk_bf16_f32 v86, v60, v61
    v_cvt_pk_bf16_f32 v87, v62, v63
    s_waitcnt lgkmcnt(2)
    v_mfma_f32_32x32x16_bf16 v[96:111], v[152:155], v[128:131], v[96:111]
    ds_read_b64_tr_b16 v[164:165], v140 offset:0
    ds_read_b64_tr_b16 v[166:167], v141 offset:0
    v_exp_f32 v64, v64
    v_exp_f32 v65, v65
    v_exp_f32 v66, v66
    v_exp_f32 v67, v67
    v_cvt_pk_bf16_f32 v88, v64, v65
    v_cvt_pk_bf16_f32 v89, v66, v67
    s_setprio 3
    v_mfma_f32_32x32x16_bf16 v[112:127], v[152:155], v[132:135], v[112:127]
    ds_read_b32 v156, v137 offset:256
    v_exp_f32 v68, v68
    v_exp_f32 v69, v69
    v_exp_f32 v70, v70
    v_exp_f32 v71, v71
    v_cvt_pk_bf16_f32 v90, v68, v69
    v_cvt_pk_bf16_f32 v91, v70, v71
    s_waitcnt lgkmcnt(3)
    v_mfma_f32_32x32x16_bf16 v[16:31], v[160:163], v[80:83], v[16:31]
    v_exp_f32 v72, v72
    v_exp_f32 v73, v73
    v_exp_f32 v74, v74
    v_exp_f32 v75, v75
    v_cvt_pk_bf16_f32 v92, v72, v73
    v_cvt_pk_bf16_f32 v93, v74, v75
    s_setprio 0
    s_waitcnt lgkmcnt(1)
    v_mfma_f32_32x32x16_bf16 v[16:31], v[164:167], v[84:87], v[16:31]
    v_exp_f32 v76, v76
    v_exp_f32 v77, v77
    v_exp_f32 v78, v78
    v_exp_f32 v79, v79
    v_cvt_pk_bf16_f32 v94, v76, v77
    v_cvt_pk_bf16_f32 v95, v78, v79
    s_waitcnt lgkmcnt(0)
    v_mfma_f32_32x32x4_2b_bf16 v[48:79], v[156:157], v[150:151], 0
    ds_read_b128 v[152:155], v136 offset:2048
    v_exp_f32 v96, v96
    v_exp_f32 v97, v97
    v_exp_f32 v98, v98
    v_exp_f32 v99, v99
    v_cvt_pk_bf16_f32 v80, v96, v97
    v_cvt_pk_bf16_f32 v81, v98, v99
    s_setprio 1
    v_exp_f32 v100, v100
    v_exp_f32 v101, v101
    v_exp_f32 v102, v102
    v_exp_f32 v103, v103
    v_cvt_pk_bf16_f32 v82, v100, v101
    v_cvt_pk_bf16_f32 v83, v102, v103
    v_mfma_f32_32x32x16_bf16 v[32:47], v[160:163], v[88:91], v[32:47]
    v_exp_f32 v104, v104
    v_exp_f32 v105, v105
    v_exp_f32 v106, v106
    v_exp_f32 v107, v107
    v_cvt_pk_bf16_f32 v84, v104, v105
    v_cvt_pk_bf16_f32 v85, v106, v107
    s_setprio 2
    v_mfma_f32_32x32x16_bf16 v[32:47], v[164:167], v[92:95], v[32:47]
    ds_read_b64_tr_b16 v[160:161], v138 offset:1280
    ds_read_b64_tr_b16 v[162:163], v139 offset:1280
    v_exp_f32 v108, v108
    v_exp_f32 v109, v109
    v_exp_f32 v110, v110
    v_exp_f32 v111, v111
    v_cvt_pk_bf16_f32 v86, v108, v109
    v_cvt_pk_bf16_f32 v87, v110, v111
    s_waitcnt lgkmcnt(2)
    v_mfma_f32_32x32x16_bf16 v[48:63], v[152:155], v[128:131], v[48:63]
    ds_read_b64_tr_b16 v[164:165], v140 offset:1280
    ds_read_b64_tr_b16 v[166:167], v141 offset:1280
    v_exp_f32 v112, v112
    v_exp_f32 v113, v113
    v_exp_f32 v114, v114
    v_exp_f32 v115, v115
    v_cvt_pk_bf16_f32 v88, v112, v113
    v_cvt_pk_bf16_f32 v89, v114, v115
    s_setprio 3
    v_mfma_f32_32x32x16_bf16 v[64:79], v[152:155], v[132:135], v[64:79]
    ds_read_b32 v156, v137 offset:384
    v_exp_f32 v116, v116
    v_exp_f32 v117, v117
    v_exp_f32 v118, v118
    v_exp_f32 v119, v119
    v_cvt_pk_bf16_f32 v90, v116, v117
    v_cvt_pk_bf16_f32 v91, v118, v119
    s_waitcnt lgkmcnt(3)
    v_mfma_f32_32x32x16_bf16 v[16:31], v[160:163], v[80:83], v[16:31]
    v_exp_f32 v120, v120
    v_exp_f32 v121, v121
    v_exp_f32 v122, v122
    v_exp_f32 v123, v123
    v_cvt_pk_bf16_f32 v92, v120, v121
    v_cvt_pk_bf16_f32 v93, v122, v123
    s_setprio 0
    s_waitcnt lgkmcnt(1)
    v_mfma_f32_32x32x16_bf16 v[16:31], v[164:167], v[84:87], v[16:31]
    v_exp_f32 v124, v124
    v_exp_f32 v125, v125
    v_exp_f32 v126, v126
    v_exp_f32 v127, v127
    v_cvt_pk_bf16_f32 v94, v124, v125
    v_cvt_pk_bf16_f32 v95, v126, v127
    s_waitcnt lgkmcnt(0)
    v_mfma_f32_32x32x4_2b_bf16 v[96:127], v[156:157], v[150:151], 0
    ds_read_b128 v[152:155], v136 offset:3072
    v_exp_f32 v48, v48
    v_exp_f32 v49, v49
    v_exp_f32 v50, v50
    v_exp_f32 v51, v51
    v_cvt_pk_bf16_f32 v80, v48, v49
    v_cvt_pk_bf16_f32 v81, v50, v51
    s_setprio 1
    v_exp_f32 v52, v52
    v_exp_f32 v53, v53
    v_exp_f32 v54, v54
    v_exp_f32 v55, v55
    v_cvt_pk_bf16_f32 v82, v52, v53
    v_cvt_pk_bf16_f32 v83, v54, v55
    v_mfma_f32_32x32x16_bf16 v[32:47], v[160:163], v[88:91], v[32:47]
    v_exp_f32 v56, v56
    v_exp_f32 v57, v57
    v_exp_f32 v58, v58
    v_exp_f32 v59, v59
    v_cvt_pk_bf16_f32 v84, v56, v57
    v_cvt_pk_bf16_f32 v85, v58, v59
    s_setprio 2
    v_mfma_f32_32x32x16_bf16 v[32:47], v[164:167], v[92:95], v[32:47]
    ds_read_b64_tr_b16 v[160:161], v138 offset:2560
    ds_read_b64_tr_b16 v[162:163], v139 offset:2560
    v_exp_f32 v60, v60
    v_exp_f32 v61, v61
    v_exp_f32 v62, v62
    v_exp_f32 v63, v63
    v_cvt_pk_bf16_f32 v86, v60, v61
    v_cvt_pk_bf16_f32 v87, v62, v63
    s_waitcnt lgkmcnt(2)
    v_mfma_f32_32x32x16_bf16 v[96:111], v[152:155], v[128:131], v[96:111]
    ds_read_b64_tr_b16 v[164:165], v140 offset:2560
    ds_read_b64_tr_b16 v[166:167], v141 offset:2560
    v_exp_f32 v64, v64
    v_exp_f32 v65, v65
    v_exp_f32 v66, v66
    v_exp_f32 v67, v67
    v_cvt_pk_bf16_f32 v88, v64, v65
    v_cvt_pk_bf16_f32 v89, v66, v67
    s_setprio 3
    v_mfma_f32_32x32x16_bf16 v[112:127], v[152:155], v[132:135], v[112:127]
    ds_read_b32 v156, v137 offset:19456
    v_exp_f32 v68, v68
    v_exp_f32 v69, v69
    v_exp_f32 v70, v70
    v_exp_f32 v71, v71
    v_cvt_pk_bf16_f32 v90, v68, v69
    v_cvt_pk_bf16_f32 v91, v70, v71
    s_waitcnt lgkmcnt(3)
    v_mfma_f32_32x32x16_bf16 v[16:31], v[160:163], v[80:83], v[16:31]
    v_exp_f32 v72, v72
    v_exp_f32 v73, v73
    v_exp_f32 v74, v74
    v_exp_f32 v75, v75
    v_cvt_pk_bf16_f32 v92, v72, v73
    v_cvt_pk_bf16_f32 v93, v74, v75
    s_setprio 0
    s_waitcnt lgkmcnt(1)
    v_mfma_f32_32x32x16_bf16 v[16:31], v[164:167], v[84:87], v[16:31]
    v_exp_f32 v76, v76
    v_exp_f32 v77, v77
    v_exp_f32 v78, v78
    v_exp_f32 v79, v79
    v_cvt_pk_bf16_f32 v94, v76, v77
    v_cvt_pk_bf16_f32 v95, v78, v79
    s_waitcnt vmcnt(0)
    s_barrier
    s_waitcnt lgkmcnt(0)
    v_mfma_f32_32x32x4_2b_bf16 v[48:79], v[156:157], v[150:151], 0
    ds_read_b128 v[152:155], v136 offset:19456
    v_exp_f32 v96, v96
    v_exp_f32 v97, v97
    v_exp_f32 v98, v98
    v_exp_f32 v99, v99
    v_cvt_pk_bf16_f32 v80, v96, v97
    v_cvt_pk_bf16_f32 v81, v98, v99
    s_setprio 1
    v_exp_f32 v100, v100
    v_exp_f32 v101, v101
    v_exp_f32 v102, v102
    v_exp_f32 v103, v103
    v_cvt_pk_bf16_f32 v82, v100, v101
    v_cvt_pk_bf16_f32 v83, v102, v103
    v_mfma_f32_32x32x16_bf16 v[32:47], v[160:163], v[88:91], v[32:47]
    v_exp_f32 v104, v104
    v_exp_f32 v105, v105
    v_exp_f32 v106, v106
    v_exp_f32 v107, v107
    v_cvt_pk_bf16_f32 v84, v104, v105
    v_cvt_pk_bf16_f32 v85, v106, v107
    s_setprio 2
    v_mfma_f32_32x32x16_bf16 v[32:47], v[164:167], v[92:95], v[32:47]
    ds_read_b64_tr_b16 v[160:161], v138 offset:3840
    ds_read_b64_tr_b16 v[162:163], v139 offset:3840
    v_exp_f32 v108, v108
    v_exp_f32 v109, v109
    v_exp_f32 v110, v110
    v_exp_f32 v111, v111
    v_cvt_pk_bf16_f32 v86, v108, v109
    v_cvt_pk_bf16_f32 v87, v110, v111
    s_waitcnt lgkmcnt(2)
    v_mfma_f32_32x32x16_bf16 v[48:63], v[152:155], v[128:131], v[48:63]
    ds_read_b64_tr_b16 v[164:165], v140 offset:3840
    ds_read_b64_tr_b16 v[166:167], v141 offset:3840
    v_exp_f32 v112, v112
    v_exp_f32 v113, v113
    v_exp_f32 v114, v114
    v_exp_f32 v115, v115
    v_cvt_pk_bf16_f32 v88, v112, v113
    v_cvt_pk_bf16_f32 v89, v114, v115
    s_setprio 3
    v_mfma_f32_32x32x16_bf16 v[64:79], v[152:155], v[132:135], v[64:79]
    ds_read_b32 v156, v137 offset:19584
    v_exp_f32 v116, v116
    v_exp_f32 v117, v117
    v_exp_f32 v118, v118
    v_exp_f32 v119, v119
    v_cvt_pk_bf16_f32 v90, v116, v117
    v_cvt_pk_bf16_f32 v91, v118, v119
    s_waitcnt lgkmcnt(3)
    v_mfma_f32_32x32x16_bf16 v[16:31], v[160:163], v[80:83], v[16:31]
    v_exp_f32 v120, v120
    v_exp_f32 v121, v121
    v_exp_f32 v122, v122
    v_exp_f32 v123, v123
    v_cvt_pk_bf16_f32 v92, v120, v121
    v_cvt_pk_bf16_f32 v93, v122, v123
    s_setprio 0
    s_waitcnt lgkmcnt(1)
    v_mfma_f32_32x32x16_bf16 v[16:31], v[164:167], v[84:87], v[16:31]
    v_exp_f32 v124, v124
    v_exp_f32 v125, v125
    v_exp_f32 v126, v126
    v_exp_f32 v127, v127
    v_cvt_pk_bf16_f32 v94, v124, v125
    v_cvt_pk_bf16_f32 v95, v126, v127
    s_waitcnt lgkmcnt(0)
    v_mfma_f32_32x32x4_2b_bf16 v[96:127], v[156:157], v[150:151], 0
    ds_read_b128 v[152:155], v136 offset:20480
    v_exp_f32 v48, v48
    v_exp_f32 v49, v49
    v_exp_f32 v50, v50
    v_exp_f32 v51, v51
    v_cvt_pk_bf16_f32 v80, v48, v49
    v_cvt_pk_bf16_f32 v81, v50, v51
    s_setprio 1
    v_exp_f32 v52, v52
    v_exp_f32 v53, v53
    v_exp_f32 v54, v54
    v_exp_f32 v55, v55
    v_cvt_pk_bf16_f32 v82, v52, v53
    v_cvt_pk_bf16_f32 v83, v54, v55
    v_mfma_f32_32x32x16_bf16 v[32:47], v[160:163], v[88:91], v[32:47]
    v_exp_f32 v56, v56
    v_exp_f32 v57, v57
    v_exp_f32 v58, v58
    v_exp_f32 v59, v59
    v_cvt_pk_bf16_f32 v84, v56, v57
    v_cvt_pk_bf16_f32 v85, v58, v59
    s_setprio 2
    v_mfma_f32_32x32x16_bf16 v[32:47], v[164:167], v[92:95], v[32:47]
    ds_read_b64_tr_b16 v[160:161], v138 offset:19456
    ds_read_b64_tr_b16 v[162:163], v139 offset:19456
    v_exp_f32 v60, v60
    v_exp_f32 v61, v61
    v_exp_f32 v62, v62
    v_exp_f32 v63, v63
    v_cvt_pk_bf16_f32 v86, v60, v61
    v_cvt_pk_bf16_f32 v87, v62, v63
    s_waitcnt lgkmcnt(2)
    v_mfma_f32_32x32x16_bf16 v[96:111], v[152:155], v[128:131], v[96:111]
    ds_read_b64_tr_b16 v[164:165], v140 offset:19456
    ds_read_b64_tr_b16 v[166:167], v141 offset:19456
    v_exp_f32 v64, v64
    v_exp_f32 v65, v65
    v_exp_f32 v66, v66
    v_exp_f32 v67, v67
    v_cvt_pk_bf16_f32 v88, v64, v65
    v_cvt_pk_bf16_f32 v89, v66, v67
    s_setprio 3
    v_mfma_f32_32x32x16_bf16 v[112:127], v[152:155], v[132:135], v[112:127]
    ds_read_b32 v156, v137 offset:19712
    v_exp_f32 v68, v68
    v_exp_f32 v69, v69
    v_exp_f32 v70, v70
    v_exp_f32 v71, v71
    v_cvt_pk_bf16_f32 v90, v68, v69
    v_cvt_pk_bf16_f32 v91, v70, v71
    s_waitcnt lgkmcnt(3)
    v_mfma_f32_32x32x16_bf16 v[16:31], v[160:163], v[80:83], v[16:31]
    v_exp_f32 v72, v72
    v_exp_f32 v73, v73
    v_exp_f32 v74, v74
    v_exp_f32 v75, v75
    v_cvt_pk_bf16_f32 v92, v72, v73
    v_cvt_pk_bf16_f32 v93, v74, v75
    s_setprio 0
    s_waitcnt lgkmcnt(1)
    v_mfma_f32_32x32x16_bf16 v[16:31], v[164:167], v[84:87], v[16:31]
    v_exp_f32 v76, v76
    v_exp_f32 v77, v77
    v_exp_f32 v78, v78
    v_exp_f32 v79, v79
    v_cvt_pk_bf16_f32 v94, v76, v77
    v_cvt_pk_bf16_f32 v95, v78, v79
    s_waitcnt lgkmcnt(0)
    v_mfma_f32_32x32x4_2b_bf16 v[48:79], v[156:157], v[150:151], 0
    ds_read_b128 v[152:155], v136 offset:21504
    v_exp_f32 v96, v96
    v_exp_f32 v97, v97
    v_exp_f32 v98, v98
    v_exp_f32 v99, v99
    v_cvt_pk_bf16_f32 v80, v96, v97
    v_cvt_pk_bf16_f32 v81, v98, v99
    s_setprio 1
    v_exp_f32 v100, v100
    v_exp_f32 v101, v101
    v_exp_f32 v102, v102
    v_exp_f32 v103, v103
    v_cvt_pk_bf16_f32 v82, v100, v101
    v_cvt_pk_bf16_f32 v83, v102, v103
    v_mfma_f32_32x32x16_bf16 v[32:47], v[160:163], v[88:91], v[32:47]
    v_exp_f32 v104, v104
    v_exp_f32 v105, v105
    v_exp_f32 v106, v106
    v_exp_f32 v107, v107
    v_cvt_pk_bf16_f32 v84, v104, v105
    v_cvt_pk_bf16_f32 v85, v106, v107
    s_setprio 2
    v_mfma_f32_32x32x16_bf16 v[32:47], v[164:167], v[92:95], v[32:47]
    ds_read_b64_tr_b16 v[160:161], v138 offset:20736
    ds_read_b64_tr_b16 v[162:163], v139 offset:20736
    v_exp_f32 v108, v108
    v_exp_f32 v109, v109
    v_exp_f32 v110, v110
    v_exp_f32 v111, v111
    v_cvt_pk_bf16_f32 v86, v108, v109
    v_cvt_pk_bf16_f32 v87, v110, v111
    s_waitcnt lgkmcnt(2)
    v_mfma_f32_32x32x16_bf16 v[48:63], v[152:155], v[128:131], v[48:63]
    ds_read_b64_tr_b16 v[164:165], v140 offset:20736
    ds_read_b64_tr_b16 v[166:167], v141 offset:20736
    v_exp_f32 v112, v112
    v_exp_f32 v113, v113
    v_exp_f32 v114, v114
    v_exp_f32 v115, v115
    v_cvt_pk_bf16_f32 v88, v112, v113
    v_cvt_pk_bf16_f32 v89, v114, v115
    s_setprio 3
    v_mfma_f32_32x32x16_bf16 v[64:79], v[152:155], v[132:135], v[64:79]
    ds_read_b32 v156, v137 offset:19840
    v_exp_f32 v116, v116
    v_exp_f32 v117, v117
    v_exp_f32 v118, v118
    v_exp_f32 v119, v119
    v_cvt_pk_bf16_f32 v90, v116, v117
    v_cvt_pk_bf16_f32 v91, v118, v119
    s_waitcnt lgkmcnt(3)
    v_mfma_f32_32x32x16_bf16 v[16:31], v[160:163], v[80:83], v[16:31]
    v_exp_f32 v120, v120
    v_exp_f32 v121, v121
    v_exp_f32 v122, v122
    v_exp_f32 v123, v123
    v_cvt_pk_bf16_f32 v92, v120, v121
    v_cvt_pk_bf16_f32 v93, v122, v123
    s_setprio 0
    s_waitcnt lgkmcnt(1)
    v_mfma_f32_32x32x16_bf16 v[16:31], v[164:167], v[84:87], v[16:31]
    v_exp_f32 v124, v124
    v_exp_f32 v125, v125
    v_exp_f32 v126, v126
    v_exp_f32 v127, v127
    v_cvt_pk_bf16_f32 v94, v124, v125
    v_cvt_pk_bf16_f32 v95, v126, v127
    s_waitcnt lgkmcnt(0)
    v_mfma_f32_32x32x4_2b_bf16 v[96:127], v[156:157], v[150:151], 0
    ds_read_b128 v[152:155], v136 offset:22528
    v_exp_f32 v48, v48
    v_exp_f32 v49, v49
    v_exp_f32 v50, v50
    v_exp_f32 v51, v51
    v_cvt_pk_bf16_f32 v80, v48, v49
    v_cvt_pk_bf16_f32 v81, v50, v51
    s_setprio 1
    v_exp_f32 v52, v52
    v_exp_f32 v53, v53
    v_exp_f32 v54, v54
    v_exp_f32 v55, v55
    v_cvt_pk_bf16_f32 v82, v52, v53
    v_cvt_pk_bf16_f32 v83, v54, v55
    v_mfma_f32_32x32x16_bf16 v[32:47], v[160:163], v[88:91], v[32:47]
    v_exp_f32 v56, v56
    v_exp_f32 v57, v57
    v_exp_f32 v58, v58
    v_exp_f32 v59, v59
    v_cvt_pk_bf16_f32 v84, v56, v57
    v_cvt_pk_bf16_f32 v85, v58, v59
    s_setprio 2
    v_mfma_f32_32x32x16_bf16 v[32:47], v[164:167], v[92:95], v[32:47]
    ds_read_b64_tr_b16 v[160:161], v138 offset:22016
    ds_read_b64_tr_b16 v[162:163], v139 offset:22016
    v_exp_f32 v60, v60
    v_exp_f32 v61, v61
    v_exp_f32 v62, v62
    v_exp_f32 v63, v63
    v_cvt_pk_bf16_f32 v86, v60, v61
    v_cvt_pk_bf16_f32 v87, v62, v63
    s_waitcnt lgkmcnt(2)
    v_mfma_f32_32x32x16_bf16 v[96:111], v[152:155], v[128:131], v[96:111]
    ds_read_b64_tr_b16 v[164:165], v140 offset:22016
    ds_read_b64_tr_b16 v[166:167], v141 offset:22016
    v_exp_f32 v64, v64
    v_exp_f32 v65, v65
    v_exp_f32 v66, v66
    v_exp_f32 v67, v67
    v_cvt_pk_bf16_f32 v88, v64, v65
    v_cvt_pk_bf16_f32 v89, v66, v67
    s_setprio 3
    v_mfma_f32_32x32x16_bf16 v[112:127], v[152:155], v[132:135], v[112:127]
    v_exp_f32 v68, v68
    v_exp_f32 v69, v69
    v_exp_f32 v70, v70
    v_exp_f32 v71, v71
    v_cvt_pk_bf16_f32 v90, v68, v69
    v_cvt_pk_bf16_f32 v91, v70, v71
    s_waitcnt lgkmcnt(2)
    v_mfma_f32_32x32x16_bf16 v[16:31], v[160:163], v[80:83], v[16:31]
    v_exp_f32 v72, v72
    v_exp_f32 v73, v73
    v_exp_f32 v74, v74
    v_exp_f32 v75, v75
    v_cvt_pk_bf16_f32 v92, v72, v73
    v_cvt_pk_bf16_f32 v93, v74, v75
    s_setprio 0
    s_waitcnt lgkmcnt(0)
    v_mfma_f32_32x32x16_bf16 v[16:31], v[164:167], v[84:87], v[16:31]
    v_exp_f32 v76, v76
    v_exp_f32 v77, v77
    v_exp_f32 v78, v78
    v_exp_f32 v79, v79
    v_cvt_pk_bf16_f32 v94, v76, v77
    v_cvt_pk_bf16_f32 v95, v78, v79
    v_exp_f32 v96, v96
    v_exp_f32 v97, v97
    v_exp_f32 v98, v98
    v_exp_f32 v99, v99
    v_cvt_pk_bf16_f32 v80, v96, v97
    v_cvt_pk_bf16_f32 v81, v98, v99
    s_setprio 1
    v_exp_f32 v100, v100
    v_exp_f32 v101, v101
    v_exp_f32 v102, v102
    v_exp_f32 v103, v103
    v_cvt_pk_bf16_f32 v82, v100, v101
    v_cvt_pk_bf16_f32 v83, v102, v103
    v_mfma_f32_32x32x16_bf16 v[32:47], v[160:163], v[88:91], v[32:47]
    v_exp_f32 v104, v104
    v_exp_f32 v105, v105
    v_exp_f32 v106, v106
    v_exp_f32 v107, v107
    v_cvt_pk_bf16_f32 v84, v104, v105
    v_cvt_pk_bf16_f32 v85, v106, v107
    s_setprio 2
    v_mfma_f32_32x32x16_bf16 v[32:47], v[164:167], v[92:95], v[32:47]
    ds_read_b64_tr_b16 v[160:161], v138 offset:23296
    ds_read_b64_tr_b16 v[162:163], v139 offset:23296
    v_exp_f32 v108, v108
    v_exp_f32 v109, v109
    v_exp_f32 v110, v110
    v_exp_f32 v111, v111
    v_cvt_pk_bf16_f32 v86, v108, v109
    v_cvt_pk_bf16_f32 v87, v110, v111
    ds_read_b64_tr_b16 v[164:165], v140 offset:23296
    ds_read_b64_tr_b16 v[166:167], v141 offset:23296
    v_exp_f32 v112, v112
    v_exp_f32 v113, v113
    v_exp_f32 v114, v114
    v_exp_f32 v115, v115
    v_cvt_pk_bf16_f32 v88, v112, v113
    v_cvt_pk_bf16_f32 v89, v114, v115
    s_setprio 3
    v_exp_f32 v116, v116
    v_exp_f32 v117, v117
    v_exp_f32 v118, v118
    v_exp_f32 v119, v119
    v_cvt_pk_bf16_f32 v90, v116, v117
    v_cvt_pk_bf16_f32 v91, v118, v119
    s_waitcnt lgkmcnt(2)
    v_mfma_f32_32x32x16_bf16 v[16:31], v[160:163], v[80:83], v[16:31]
    v_exp_f32 v120, v120
    v_exp_f32 v121, v121
    v_exp_f32 v122, v122
    v_exp_f32 v123, v123
    v_cvt_pk_bf16_f32 v92, v120, v121
    v_cvt_pk_bf16_f32 v93, v122, v123
    s_setprio 0
    s_waitcnt lgkmcnt(0)
    v_mfma_f32_32x32x16_bf16 v[16:31], v[164:167], v[84:87], v[16:31]
    v_exp_f32 v124, v124
    v_exp_f32 v125, v125
    v_exp_f32 v126, v126
    v_exp_f32 v127, v127
    v_cvt_pk_bf16_f32 v94, v124, v125
    v_cvt_pk_bf16_f32 v95, v126, v127
    s_setprio 0
    v_mfma_f32_32x32x16_bf16 v[32:47], v[160:163], v[88:91], v[32:47]
    v_mfma_f32_32x32x16_bf16 v[32:47], v[164:167], v[92:95], v[32:47]
    v_mov_b32 v2, 0
    v_mov_b32 v3, 0
    v_mov_b32 v4, 0x71800000
    s_lshl_b32 s27, s20, 2
    s_add_u32 s27, s27, 155648
    v_mov_b32 v5, s27
    v_pk_fma_f32 v[2:3], v[16:17], 0, v[2:3]
    v_pk_fma_f32 v[2:3], v[18:19], 0, v[2:3]
    v_pk_fma_f32 v[2:3], v[20:21], 0, v[2:3]
    v_pk_fma_f32 v[2:3], v[22:23], 0, v[2:3]
    v_pk_fma_f32 v[2:3], v[24:25], 0, v[2:3]
    v_pk_fma_f32 v[2:3], v[26:27], 0, v[2:3]
    v_cmp_nle_f32 s[40:41], v26, v4
    v_pk_fma_f32 v[2:3], v[32:33], 0, v[2:3]
    v_pk_fma_f32 v[2:3], v[34:35], 0, v[2:3]
    v_pk_fma_f32 v[2:3], v[36:37], 0, v[2:3]
    v_pk_fma_f32 v[2:3], v[38:39], 0, v[2:3]
    v_pk_fma_f32 v[2:3], v[40:41], 0, v[2:3]
    v_pk_fma_f32 v[2:3], v[42:43], 0, v[2:3]
    ds_write_b128 v144, v[32:35] offset:0
    ds_write_b128 v144, v[36:39] offset:1024
    ds_write_b128 v144, v[40:43] offset:2048
    v_cmp_nle_f32 s[42:43], v42, v4
    v_cmp_u_f32 vcc, v2, v3
    s_or_b64 s[40:41], s[40:41], s[42:43]
    s_or_b64 s[40:41], s[40:41], vcc
    s_cmp_lg_u64 s[40:41], 0
    s_cselect_b32 s26, 1, 0
    v_mov_b32 v1, s26
    s_mov_b64 exec, 1
    ds_write_b32 v5, v1
    s_mov_b64 exec, -1
    s_waitcnt lgkmcnt(0)
    s_barrier
    ds_read_b32 v1, v148
    ds_read_b128 v[32:35], v145 offset:0
    ds_read_b128 v[36:39], v145 offset:1024
    ds_read_b128 v[40:43], v145 offset:2048
    s_waitcnt lgkmcnt(0)
    v_cmp_ne_u32 s[40:41], 0, v1
    v_add_f32 v26, v26, v42
    v_pk_add_f32 v[16:17], v[16:17], v[32:33]
    v_pk_add_f32 v[18:19], v[18:19], v[34:35]
    v_pk_add_f32 v[20:21], v[20:21], v[36:37]
    v_pk_add_f32 v[22:23], v[22:23], v[38:39]
    v_pk_add_f32 v[24:25], v[24:25], v[40:41]
    s_cmp_lg_u64 s[40:41], 0
    s_cbranch_scc1 L_f3_kernel_slow
    v_mov_b32 v1, v26
    s_nop 1
    v_permlane32_swap_b32 v26, v1
    v_rcp_f32 v26, v26
    s_nop 0
    v_mul_f32 v16, v16, v26
    v_mul_f32 v17, v17, v26
    v_mul_f32 v18, v18, v26
    v_mul_f32 v19, v19, v26
    v_mul_f32 v20, v20, v26
    v_mul_f32 v21, v21, v26
    v_mul_f32 v22, v22, v26
    v_mul_f32 v23, v23, v26
    v_mul_f32 v24, v24, v26
    v_mul_f32 v25, v25, v26
    v_cvt_pk_bf16_f32 v16, v16, v17
    v_cvt_pk_bf16_f32 v17, v18, v19
    v_cvt_pk_bf16_f32 v18, v20, v21
    v_cvt_pk_bf16_f32 v19, v22, v23
    v_cvt_pk_bf16_f32 v20, v24, v25
L_f3_kernel_tail:
    buffer_store_dwordx4 v[16:19], v146, s[4:7], s36 offen sc1
    buffer_store_dword v20, v147, s[4:7], s39 offen sc1
    s_lshr_b32 s26, s21, 3
    s_lshl_b32 s26, s26, 1
    s_and_b32 s27, s20, 1
    s_add_u32 s26, s26, s27
    s_lshl_b32 s28, s22, 3
    s_add_u32 s26, s26, s28
    s_lshl_b32 s26, s26, 5
    s_bfe_u32 s28, s20, 0x10001
    s_and_b32 s29, s21, 7
    s_mul_i32 s29, s29, 144
    s_mul_i32 s30, s27, 36864
    s_add_u32 s30, s30, 82944
    s_mul_i32 s31, s27, 9216
    s_add_u32 s31, s31, 107520
    s_lshl_b32 s32, s23, 1
    s_add_u32 s32, s32, s24
    s_lshl_b32 s33, s22, 3
    s_add_u32 s32, s32, s33
    s_lshl_b32 s32, s32, 8
    s_add_u32 s32, s32, s21
    s_lshl_b32 s32, s32, 2
    s_add_u32 s32, s32, 36864
    v_mov_b32 v9, 268435456
    v_lshlrev_b32 v11, 7, v0
    v_cmp_gt_u32 vcc, 8, v0
    s_nop 1
    v_cndmask_b32 v9, v9, v11, vcc
    buffer_store_dword v159, v9, s[4:7], s32 offen sc1
    s_add_u32 s32, s32, 65536
    s_mov_b32 s8, s92
    s_mov_b32 s9, s93
    s_mov_b32 s10, 2359296
    s_mov_b32 s11, 0x00020000
    v_lshlrev_b32 v10, 4, v0
    s_cmp_lg_u32 s24, 0
    s_cbranch_scc1 L_rem_37
    v_and_b32 v11, 31, v0
    v_add_u32 v11, s26, v11
    v_lshlrev_b32 v1, 2, v11
    buffer_load_dword v1, v1, s[4:7], 0 offen offset:0 sc1
    s_lshl_b32 s33, s28, 10
    v_add_u32 v5, s33, v10
    v_add_u32 v6, 41472, v5
    v_add_u32 v4, s30, v10
    s_lshl_b32 s33, s28, 12
    s_add_u32 s33, s33, s31
    v_add_u32 v7, s33, v10
    s_lshl_b32 s33, s28, 6
    s_add_u32 s33, s33, s29
    v_mul_u32_u24 v11, 1152, v11
    v_lshrrev_b32 v12, 5, v0
    v_lshl_add_u32 v11, v12, 4, v11
    v_add_u32 v8, s33, v11
    ds_read_b128 v[48:51], v5 offset:0
    ds_read_b128 v[52:55], v5 offset:2304
    ds_read_b128 v[56:59], v5 offset:4608
    ds_read_b128 v[60:63], v5 offset:6912
    ds_read_b128 v[64:67], v5 offset:9216
    ds_read_b128 v[68:71], v5 offset:11520
    ds_read_b128 v[72:75], v5 offset:13824
    ds_read_b128 v[76:79], v5 offset:16128
    ds_read_b128 v[80:83], v5 offset:18432
    ds_read_b128 v[84:87], v5 offset:20736
    ds_read_b128 v[88:91], v5 offset:23040
    ds_read_b128 v[92:95], v5 offset:25344
    ds_read_b128 v[96:99], v5 offset:27648
    ds_read_b128 v[100:103], v5 offset:29952
    ds_read_b128 v[104:107], v5 offset:32256
    ds_read_b128 v[108:111], v5 offset:34560
    ds_read_b128 v[112:115], v5 offset:36864
    ds_read_b128 v[116:119], v5 offset:39168
    ds_read_b128 v[120:123], v6 offset:0
    ds_read_b128 v[124:127], v6 offset:2304
    ds_read_b128 v[128:131], v6 offset:4608
    ds_read_b128 v[132:135], v6 offset:6912
    ds_read_b128 v[136:139], v6 offset:9216
    ds_read_b128 v[140:143], v6 offset:11520
    s_barrier
    ds_read_b128 v[32:35], v7 offset:0
    ds_read_b128 v[36:39], v7 offset:1024
    ds_read_b128 v[40:43], v7 offset:2048
    ds_read_b128 v[44:47], v7 offset:3072
    ds_read_b128 v[16:19], v7 offset:18432
    ds_read_b128 v[20:23], v7 offset:19456
    ds_read_b128 v[24:27], v7 offset:20480
    ds_read_b128 v[28:31], v7 offset:21504
    s_waitcnt lgkmcnt(0)
    s_barrier
    s_waitcnt vmcnt(1)
    buffer_store_dword v159, v9, s[4:7], s32 offen sc1
    s_waitcnt vmcnt(1) lgkmcnt(0)
    v_sub_f32 v2, 1.0, v1
    v_sub_f32 v3, 1.0, v1
    v_pk_add_f32 v[32:33], v[32:33], v[16:17]
    v_pk_add_f32 v[34:35], v[34:35], v[18:19]
    v_pk_add_f32 v[36:37], v[36:37], v[20:21]
    v_pk_add_f32 v[38:39], v[38:39], v[22:23]
    v_pk_add_f32 v[40:41], v[40:41], v[24:25]
    v_pk_add_f32 v[42:43], v[42:43], v[26:27]
    v_pk_add_f32 v[44:45], v[44:45], v[28:29]
    v_pk_add_f32 v[46:47], v[46:47], v[30:31]
    v_mul_f32 v32, v32, v1
    v_mul_f32 v33, v33, v1
    v_mul_f32 v34, v34, v1
    v_mul_f32 v35, v35, v1
    v_mul_f32 v36, v36, v1
    v_mul_f32 v37, v37, v1
    v_mul_f32 v38, v38, v1
    v_mul_f32 v39, v39, v1
    v_mul_f32 v40, v40, v1
    v_mul_f32 v41, v41, v1
    v_mul_f32 v42, v42, v1
    v_mul_f32 v43, v43, v1
    v_mul_f32 v44, v44, v1
    v_mul_f32 v45, v45, v1
    v_mul_f32 v46, v46, v1
    v_mul_f32 v47, v47, v1
    v_and_b32 v11, 31, v0
    v_lshrrev_b32 v12, 5, v0
    v_lshlrev_b32 v12, 9, v12
    v_lshl_add_u32 v12, v11, 2, v12
    v_add_u32 v10, s30, v12
    v_mov_b32 v13, 0
    s_barrier
    ds_read_b32 v144, v10 offset:0
    ds_read_b32 v145, v10 offset:128
    ds_read_b32 v146, v10 offset:256
    ds_read_b32 v147, v10 offset:384
    ds_read_b32 v148, v10 offset:1024
    ds_read_b32 v149, v10 offset:1152
    ds_read_b32 v150, v10 offset:1280
    ds_read_b32 v151, v10 offset:1408
    ds_read_b32 v152, v10 offset:2048
    ds_read_b32 v153, v10 offset:2176
    ds_read_b32 v154, v10 offset:2304
    ds_read_b32 v155, v10 offset:2432
    ds_read_b32 v156, v10 offset:3072
    ds_read_b32 v157, v10 offset:3200
    ds_read_b32 v158, v10 offset:3328
    ds_read_b32 v159, v10 offset:3456
    ds_read_b128 v[160:163], v4 offset:4096
    ds_read_b128 v[164:167], v4 offset:5120
    s_waitcnt lgkmcnt(14)
    v_mfma_f32_32x32x16_bf16 v[16:31], v[48:51], v[144:147], 0
    v_max3_u32 v13, v144, v145, v13
    v_max3_u32 v13, v146, v147, v13
    ds_read_b128 v[48:51], v6 offset:13824
    ds_read_b128 v[144:147], v4 offset:6144
    s_waitcnt lgkmcnt(12)
    v_mfma_f32_32x32x16_bf16 v[16:31], v[52:55], v[148:151], v[16:31]
    v_max3_u32 v13, v148, v149, v13
    v_max3_u32 v13, v150, v151, v13
    ds_read_b128 v[52:55], v6 offset:16128
    ds_read_b128 v[148:151], v4 offset:7168
    s_waitcnt lgkmcnt(10)
    v_mfma_f32_32x32x16_bf16 v[16:31], v[56:59], v[152:155], v[16:31]
    v_max3_u32 v13, v152, v153, v13
    v_max3_u32 v13, v154, v155, v13
    ds_read_b128 v[56:59], v6 offset:18432
    s_waitcnt lgkmcnt(7)
    v_mfma_f32_32x32x16_bf16 v[16:31], v[60:63], v[156:159], v[16:31]
    v_max3_u32 v13, v156, v157, v13
    v_max3_u32 v13, v158, v159, v13
    ds_read_b128 v[60:63], v6 offset:20736
    s_waitcnt lgkmcnt(7)
    v_mfma_f32_32x32x16_bf16 v[16:31], v[64:67], v[160:163], v[16:31]
    v_max3_u32 v13, v160, v163, v13
    ds_read_b128 v[64:67], v6 offset:23040
    s_barrier
    ds_read_b128 v[152:155], v4 offset:8192
    ds_read_b128 v[156:159], v4 offset:9216
    ds_read_b128 v[160:163], v4 offset:10240
    s_waitcnt lgkmcnt(10)
    v_mfma_f32_32x32x16_bf16 v[16:31], v[68:71], v[164:167], v[16:31]
    v_max3_u32 v13, v164, v167, v13
    ds_read_b128 v[68:71], v6 offset:25344
    ds_read_b128 v[164:167], v4 offset:11264
    s_waitcnt lgkmcnt(10)
    v_mfma_f32_32x32x16_bf16 v[16:31], v[72:75], v[144:147], v[16:31]
    v_max3_u32 v13, v144, v147, v13
    ds_read_b128 v[72:75], v6 offset:27648
    ds_read_b128 v[144:147], v4 offset:12288
    s_waitcnt lgkmcnt(10)
    v_mfma_f32_32x32x16_bf16 v[16:31], v[76:79], v[148:151], v[16:31]
    v_max3_u32 v13, v148, v151, v13
    ds_read_b128 v[76:79], v6 offset:29952
    ds_read_b128 v[148:151], v4 offset:13312
    s_waitcnt lgkmcnt(8)
    v_mfma_f32_32x32x16_bf16 v[16:31], v[80:83], v[152:155], v[16:31]
    v_max3_u32 v13, v152, v155, v13
    ds_read_b128 v[80:83], v6 offset:32256
    ds_read_b128 v[152:155], v4 offset:14336
    s_waitcnt lgkmcnt(9)
    v_mfma_f32_32x32x16_bf16 v[16:31], v[84:87], v[156:159], v[16:31]
    v_max3_u32 v13, v156, v159, v13
    ds_read_b128 v[84:87], v6 offset:34560
    ds_read_b128 v[156:159], v4 offset:15360
    s_waitcnt lgkmcnt(10)
    v_mfma_f32_32x32x16_bf16 v[16:31], v[88:91], v[160:163], v[16:31]
    v_max3_u32 v13, v160, v163, v13
    ds_read_b128 v[88:91], v6 offset:36864
    s_waitcnt lgkmcnt(9)
    v_mfma_f32_32x32x16_bf16 v[16:31], v[92:95], v[164:167], v[16:31]
    v_max3_u32 v13, v164, v167, v13
    ds_read_b128 v[92:95], v6 offset:39168
    s_waitcnt lgkmcnt(8)
    v_mfma_f32_32x32x16_bf16 v[16:31], v[96:99], v[144:147], v[16:31]
    v_max3_u32 v13, v144, v147, v13
    s_barrier
    ds_read_b128 v[160:163], v4 offset:16384
    ds_read_b128 v[164:167], v4 offset:17408
    ds_read_b128 v[144:147], v4 offset:18432
    s_waitcnt lgkmcnt(9)
    v_mfma_f32_32x32x16_bf16 v[16:31], v[100:103], v[148:151], v[16:31]
    v_max3_u32 v13, v148, v151, v13
    ds_read_b128 v[148:151], v4 offset:19456
    s_waitcnt lgkmcnt(8)
    v_mfma_f32_32x32x16_bf16 v[16:31], v[104:107], v[152:155], v[16:31]
    v_max3_u32 v13, v152, v155, v13
    ds_read_b128 v[152:155], v4 offset:20480
    s_waitcnt lgkmcnt(7)
    v_mfma_f32_32x32x16_bf16 v[16:31], v[108:111], v[156:159], v[16:31]
    v_max3_u32 v13, v156, v159, v13
    ds_read_b128 v[156:159], v4 offset:21504
    s_waitcnt lgkmcnt(5)
    v_mfma_f32_32x32x16_bf16 v[16:31], v[112:115], v[160:163], v[16:31]
    v_max3_u32 v13, v160, v163, v13
    ds_read_b128 v[160:163], v4 offset:22528
    s_waitcnt lgkmcnt(5)
    v_mfma_f32_32x32x16_bf16 v[16:31], v[116:119], v[164:167], v[16:31]
    v_max3_u32 v13, v164, v167, v13
    ds_read_b128 v[164:167], v4 offset:23552
    s_waitcnt lgkmcnt(5)
    v_mfma_f32_32x32x16_bf16 v[16:31], v[120:123], v[144:147], v[16:31]
    v_max3_u32 v13, v144, v147, v13
    s_waitcnt lgkmcnt(4)
    v_mfma_f32_32x32x16_bf16 v[16:31], v[124:127], v[148:151], v[16:31]
    v_max3_u32 v13, v148, v151, v13
    s_waitcnt lgkmcnt(3)
    v_mfma_f32_32x32x16_bf16 v[16:31], v[128:131], v[152:155], v[16:31]
    v_max3_u32 v13, v152, v155, v13
    s_barrier
    ds_read_b128 v[144:147], v4 offset:24576
    ds_read_b128 v[148:151], v4 offset:25600
    ds_read_b128 v[152:155], v4 offset:26624
    s_waitcnt lgkmcnt(5)
    v_mfma_f32_32x32x16_bf16 v[16:31], v[132:135], v[156:159], v[16:31]
    v_max3_u32 v13, v156, v159, v13
    ds_read_b128 v[156:159], v4 offset:27648
    s_waitcnt lgkmcnt(5)
    v_mfma_f32_32x32x16_bf16 v[16:31], v[136:139], v[160:163], v[16:31]
    v_max3_u32 v13, v160, v163, v13
    ds_read_b128 v[160:163], v4 offset:28672
    s_waitcnt lgkmcnt(5)
    v_mfma_f32_32x32x16_bf16 v[16:31], v[140:143], v[164:167], v[16:31]
    v_max3_u32 v13, v164, v167, v13
    ds_read_b128 v[164:167], v4 offset:29696
    s_waitcnt lgkmcnt(5)
    v_mfma_f32_32x32x16_bf16 v[16:31], v[48:51], v[144:147], v[16:31]
    v_max3_u32 v13, v144, v147, v13
    s_waitcnt lgkmcnt(4)
    v_mfma_f32_32x32x16_bf16 v[16:31], v[52:55], v[148:151], v[16:31]
    v_max3_u32 v13, v148, v151, v13
    s_waitcnt lgkmcnt(3)
    v_mfma_f32_32x32x16_bf16 v[16:31], v[56:59], v[152:155], v[16:31]
    v_max3_u32 v13, v152, v155, v13
    s_barrier
    ds_read_b128 v[144:147], v4 offset:30720
    ds_read_b128 v[148:151], v4 offset:31744
    ds_read_b128 v[152:155], v4 offset:32768
    s_waitcnt lgkmcnt(5)
    v_mfma_f32_32x32x16_bf16 v[16:31], v[60:63], v[156:159], v[16:31]
    v_max3_u32 v13, v156, v159, v13
    ds_read_b128 v[156:159], v4 offset:33792
    s_waitcnt lgkmcnt(5)
    v_mfma_f32_32x32x16_bf16 v[16:31], v[64:67], v[160:163], v[16:31]
    v_max3_u32 v13, v160, v163, v13
    s_waitcnt lgkmcnt(4)
    v_mfma_f32_32x32x16_bf16 v[16:31], v[68:71], v[164:167], v[16:31]
    v_max3_u32 v13, v164, v167, v13
    s_waitcnt lgkmcnt(3)
    v_mfma_f32_32x32x16_bf16 v[16:31], v[72:75], v[144:147], v[16:31]
    v_max3_u32 v13, v144, v147, v13
    s_barrier
    ds_read_b128 v[160:163], v4 offset:34816
    ds_read_b128 v[164:167], v4 offset:35840
    s_waitcnt lgkmcnt(4)
    v_mfma_f32_32x32x16_bf16 v[16:31], v[76:79], v[148:151], v[16:31]
    v_max3_u32 v13, v148, v151, v13
    s_waitcnt lgkmcnt(3)
    v_mfma_f32_32x32x16_bf16 v[16:31], v[80:83], v[152:155], v[16:31]
    v_max3_u32 v13, v152, v155, v13
    s_waitcnt lgkmcnt(2)
    v_mfma_f32_32x32x16_bf16 v[16:31], v[84:87], v[156:159], v[16:31]
    v_max3_u32 v13, v156, v159, v13
    s_waitcnt lgkmcnt(1)
    v_mfma_f32_32x32x16_bf16 v[16:31], v[88:91], v[160:163], v[16:31]
    v_max3_u32 v13, v160, v163, v13
    s_waitcnt lgkmcnt(0)
    v_mfma_f32_32x32x16_bf16 v[16:31], v[92:95], v[164:167], v[16:31]
    v_max3_u32 v13, v164, v167, v13
    v_cmp_eq_u32 vcc, -1, v13
    s_cmp_lg_u64 vcc, 0
    s_cbranch_scc1 L_fb_38
L_bk_39:
    s_nop 7
    v_pk_fma_f32 v[16:17], v[16:17], v[2:3], v[32:33]
    v_pk_fma_f32 v[18:19], v[18:19], v[2:3], v[34:35]
    v_pk_fma_f32 v[20:21], v[20:21], v[2:3], v[36:37]
    v_pk_fma_f32 v[22:23], v[22:23], v[2:3], v[38:39]
    v_pk_fma_f32 v[24:25], v[24:25], v[2:3], v[40:41]
    v_pk_fma_f32 v[26:27], v[26:27], v[2:3], v[42:43]
    v_pk_fma_f32 v[28:29], v[28:29], v[2:3], v[44:45]
    v_pk_fma_f32 v[30:31], v[30:31], v[2:3], v[46:47]
    v_cvt_pk_bf16_f32 v16, v16, v17
    v_cvt_pk_bf16_f32 v17, v18, v19
    v_cvt_pk_bf16_f32 v18, v20, v21
    v_cvt_pk_bf16_f32 v19, v22, v23
    v_cvt_pk_bf16_f32 v20, v24, v25
    v_cvt_pk_bf16_f32 v21, v26, v27
    v_cvt_pk_bf16_f32 v22, v28, v29
    v_cvt_pk_bf16_f32 v23, v30, v31
    buffer_store_dwordx4 v[16:19], v8, s[8:11], 0 offen
    buffer_store_dwordx4 v[20:23], v8, s[8:11], 0 offen offset:32
    s_endpgm
L_fb_38:
    s_mov_b32 s16, s54
    s_mov_b32 s17, s55
    s_mov_b32 s18, 256
    s_mov_b32 s19, 0x00020000
    v_bfe_u32 v14, v0, 3, 2
    v_lshlrev_b32 v14, 6, v14
    buffer_load_dword v15, v14, s[16:19], 0 offen sc1
    s_lshr_b32 s29, s26, 5
    s_lshl_b32 s31, s29, 3
    s_and_b32 s33, s21, 7
    s_add_u32 s31, s31, s33
    s_lshl_b32 s31, s31, 7
    s_add_u32 s31, s31, 102400
    s_mul_i32 s29, s29, 36864
    s_add_u32 s29, s29, 17047552
    v_and_b32 v12, 31, v0
    v_lshlrev_b32 v12, 2, v12
    v_subrev_u32 v4, s30, v4
    v_subrev_u32 v10, s30, v10
    s_mov_b32 s33, 0
L_fpl_40:
    buffer_load_dword v14, v12, s[4:7], s31 offen sc1
    s_add_u32 s33, s33, 1
    s_cmp_ge_u32 s33, 65536
    s_cbranch_scc1 L_fpd_41
    s_waitcnt vmcnt(0)
    v_cmp_eq_u32 vcc, v14, v15
    s_cmp_eq_u64 vcc, -1
    s_cbranch_scc0 L_fpl_40
L_fpd_41:
    s_waitcnt vmcnt(0)
    buffer_load_dword v144, v10, s[4:7], s29 offen offset:0 sc1
    buffer_load_dword v145, v10, s[4:7], s29 offen offset:128 sc1
    buffer_load_dword v146, v10, s[4:7], s29 offen offset:256 sc1
    buffer_load_dword v147, v10, s[4:7], s29 offen offset:384 sc1
    ds_read_b128 v[48:51], v5 offset:0
    s_add_u32 s29, s29, 1024
    buffer_load_dword v148, v10, s[4:7], s29 offen offset:0 sc1
    buffer_load_dword v149, v10, s[4:7], s29 offen offset:128 sc1
    buffer_load_dword v150, v10, s[4:7], s29 offen offset:256 sc1
    buffer_load_dword v151, v10, s[4:7], s29 offen offset:384 sc1
    ds_read_b128 v[52:55], v5 offset:2304
    s_add_u32 s29, s29, 1024
    buffer_load_dword v152, v10, s[4:7], s29 offen offset:0 sc1
    buffer_load_dword v153, v10, s[4:7], s29 offen offset:128 sc1
    buffer_load_dword v154, v10, s[4:7], s29 offen offset:256 sc1
    buffer_load_dword v155, v10, s[4:7], s29 offen offset:384 sc1
    ds_read_b128 v[56:59], v5 offset:4608
    s_add_u32 s29, s29, 1024
    buffer_load_dword v156, v10, s[4:7], s29 offen offset:0 sc1
    buffer_load_dword v157, v10, s[4:7], s29 offen offset:128 sc1
    buffer_load_dword v158, v10, s[4:7], s29 offen offset:256 sc1
    buffer_load_dword v159, v10, s[4:7], s29 offen offset:384 sc1
    ds_read_b128 v[60:63], v5 offset:6912
    s_add_u32 s29, s29, 1024
    buffer_load_dwordx4 v[160:163], v4, s[4:7], s29 offen sc1
    ds_read_b128 v[64:67], v5 offset:9216
    s_add_u32 s29, s29, 1024
    buffer_load_dwordx4 v[164:167], v4, s[4:7], s29 offen sc1
    ds_read_b128 v[68:71], v5 offset:11520
    s_add_u32 s29, s29, 1024
    s_waitcnt vmcnt(0) lgkmcnt(0)
    v_mfma_f32_32x32x16_bf16 v[16:31], v[48:51], v[144:147], 0
    v_mfma_f32_32x32x16_bf16 v[16:31], v[52:55], v[148:151], v[16:31]
    v_mfma_f32_32x32x16_bf16 v[16:31], v[56:59], v[152:155], v[16:31]
    v_mfma_f32_32x32x16_bf16 v[16:31], v[60:63], v[156:159], v[16:31]
    v_mfma_f32_32x32x16_bf16 v[16:31], v[64:67], v[160:163], v[16:31]
    v_mfma_f32_32x32x16_bf16 v[16:31], v[68:71], v[164:167], v[16:31]
    buffer_load_dwordx4 v[144:147], v4, s[4:7], s29 offen sc1
    ds_read_b128 v[48:51], v5 offset:13824
    s_add_u32 s29, s29, 1024
    buffer_load_dwordx4 v[148:151], v4, s[4:7], s29 offen sc1
    ds_read_b128 v[52:55], v5 offset:16128
    s_add_u32 s29, s29, 1024
    buffer_load_dwordx4 v[152:155], v4, s[4:7], s29 offen sc1
    ds_read_b128 v[56:59], v5 offset:18432
    s_add_u32 s29, s29, 1024
    buffer_load_dwordx4 v[156:159], v4, s[4:7], s29 offen sc1
    ds_read_b128 v[60:63], v5 offset:20736
    s_add_u32 s29, s29, 1024
    buffer_load_dwordx4 v[160:163], v4, s[4:7], s29 offen sc1
    ds_read_b128 v[64:67], v5 offset:23040
    s_add_u32 s29, s29, 1024
    buffer_load_dwordx4 v[164:167], v4, s[4:7], s29 offen sc1
    ds_read_b128 v[68:71], v5 offset:25344
    s_add_u32 s29, s29, 1024
    s_waitcnt vmcnt(0) lgkmcnt(0)
    v_mfma_f32_32x32x16_bf16 v[16:31], v[48:51], v[144:147], v[16:31]
    v_mfma_f32_32x32x16_bf16 v[16:31], v[52:55], v[148:151], v[16:31]
    v_mfma_f32_32x32x16_bf16 v[16:31], v[56:59], v[152:155], v[16:31]
    v_mfma_f32_32x32x16_bf16 v[16:31], v[60:63], v[156:159], v[16:31]
    v_mfma_f32_32x32x16_bf16 v[16:31], v[64:67], v[160:163], v[16:31]
    v_mfma_f32_32x32x16_bf16 v[16:31], v[68:71], v[164:167], v[16:31]
    buffer_load_dwordx4 v[144:147], v4, s[4:7], s29 offen sc1
    ds_read_b128 v[48:51], v5 offset:27648
    s_add_u32 s29, s29, 1024
    buffer_load_dwordx4 v[148:151], v4, s[4:7], s29 offen sc1
    ds_read_b128 v[52:55], v5 offset:29952
    s_add_u32 s29, s29, 1024
    buffer_load_dwordx4 v[152:155], v4, s[4:7], s29 offen sc1
    ds_read_b128 v[56:59], v5 offset:32256
    s_add_u32 s29, s29, 1024
    buffer_load_dwordx4 v[156:159], v4, s[4:7], s29 offen sc1
    ds_read_b128 v[60:63], v5 offset:34560
    s_add_u32 s29, s29, 1024
    buffer_load_dwordx4 v[160:163], v4, s[4:7], s29 offen sc1
    ds_read_b128 v[64:67], v5 offset:36864
    s_add_u32 s29, s29, 1024
    buffer_load_dwordx4 v[164:167], v4, s[4:7], s29 offen sc1
    ds_read_b128 v[68:71], v5 offset:39168
    s_add_u32 s29, s29, 1024
    s_waitcnt vmcnt(0) lgkmcnt(0)
    v_mfma_f32_32x32x16_bf16 v[16:31], v[48:51], v[144:147], v[16:31]
    v_mfma_f32_32x32x16_bf16 v[16:31], v[52:55], v[148:151], v[16:31]
    v_mfma_f32_32x32x16_bf16 v[16:31], v[56:59], v[152:155], v[16:31]
    v_mfma_f32_32x32x16_bf16 v[16:31], v[60:63], v[156:159], v[16:31]
    v_mfma_f32_32x32x16_bf16 v[16:31], v[64:67], v[160:163], v[16:31]
    v_mfma_f32_32x32x16_bf16 v[16:31], v[68:71], v[164:167], v[16:31]
    buffer_load_dwordx4 v[144:147], v4, s[4:7], s29 offen sc1
    ds_read_b128 v[48:51], v6 offset:0
    s_add_u32 s29, s29, 1024
    buffer_load_dwordx4 v[148:151], v4, s[4:7], s29 offen sc1
    ds_read_b128 v[52:55], v6 offset:2304
    s_add_u32 s29, s29, 1024
    buffer_load_dwordx4 v[152:155], v4, s[4:7], s29 offen sc1
    ds_read_b128 v[56:59], v6 offset:4608
    s_add_u32 s29, s29, 1024
    buffer_load_dwordx4 v[156:159], v4, s[4:7], s29 offen sc1
    ds_read_b128 v[60:63], v6 offset:6912
    s_add_u32 s29, s29, 1024
    buffer_load_dwordx4 v[160:163], v4, s[4:7], s29 offen sc1
    ds_read_b128 v[64:67], v6 offset:9216
    s_add_u32 s29, s29, 1024
    buffer_load_dwordx4 v[164:167], v4, s[4:7], s29 offen sc1
    ds_read_b128 v[68:71], v6 offset:11520
    s_add_u32 s29, s29, 1024
    s_waitcnt vmcnt(0) lgkmcnt(0)
    v_mfma_f32_32x32x16_bf16 v[16:31], v[48:51], v[144:147], v[16:31]
    v_mfma_f32_32x32x16_bf16 v[16:31], v[52:55], v[148:151], v[16:31]
    v_mfma_f32_32x32x16_bf16 v[16:31], v[56:59], v[152:155], v[16:31]
    v_mfma_f32_32x32x16_bf16 v[16:31], v[60:63], v[156:159], v[16:31]
    v_mfma_f32_32x32x16_bf16 v[16:31], v[64:67], v[160:163], v[16:31]
    v_mfma_f32_32x32x16_bf16 v[16:31], v[68:71], v[164:167], v[16:31]
    buffer_load_dwordx4 v[144:147], v4, s[4:7], s29 offen sc1
    ds_read_b128 v[48:51], v6 offset:13824
    s_add_u32 s29, s29, 1024
    buffer_load_dwordx4 v[148:151], v4, s[4:7], s29 offen sc1
    ds_read_b128 v[52:55], v6 offset:16128
    s_add_u32 s29, s29, 1024
    buffer_load_dwordx4 v[152:155], v4, s[4:7], s29 offen sc1
    ds_read_b128 v[56:59], v6 offset:18432
    s_add_u32 s29, s29, 1024
    buffer_load_dwordx4 v[156:159], v4, s[4:7], s29 offen sc1
    ds_read_b128 v[60:63], v6 offset:20736
    s_add_u32 s29, s29, 1024
    buffer_load_dwordx4 v[160:163], v4, s[4:7], s29 offen sc1
    ds_read_b128 v[64:67], v6 offset:23040
    s_add_u32 s29, s29, 1024
    buffer_load_dwordx4 v[164:167], v4, s[4:7], s29 offen sc1
    ds_read_b128 v[68:71], v6 offset:25344
    s_add_u32 s29, s29, 1024
    s_waitcnt vmcnt(0) lgkmcnt(0)
    v_mfma_f32_32x32x16_bf16 v[16:31], v[48:51], v[144:147], v[16:31]
    v_mfma_f32_32x32x16_bf16 v[16:31], v[52:55], v[148:151], v[16:31]
    v_mfma_f32_32x32x16_bf16 v[16:31], v[56:59], v[152:155], v[16:31]
    v_mfma_f32_32x32x16_bf16 v[16:31], v[60:63], v[156:159], v[16:31]
    v_mfma_f32_32x32x16_bf16 v[16:31], v[64:67], v[160:163], v[16:31]
    v_mfma_f32_32x32x16_bf16 v[16:31], v[68:71], v[164:167], v[16:31]
    buffer_load_dwordx4 v[144:147], v4, s[4:7], s29 offen sc1
    ds_read_b128 v[48:51], v6 offset:27648
    s_add_u32 s29, s29, 1024
    buffer_load_dwordx4 v[148:151], v4, s[4:7], s29 offen sc1
    ds_read_b128 v[52:55], v6 offset:29952
    s_add_u32 s29, s29, 1024
    buffer_load_dwordx4 v[152:155], v4, s[4:7], s29 offen sc1
    ds_read_b128 v[56:59], v6 offset:32256
    s_add_u32 s29, s29, 1024
    buffer_load_dwordx4 v[156:159], v4, s[4:7], s29 offen sc1
    ds_read_b128 v[60:63], v6 offset:34560
    s_add_u32 s29, s29, 1024
    buffer_load_dwordx4 v[160:163], v4, s[4:7], s29 offen sc1
    ds_read_b128 v[64:67], v6 offset:36864
    s_add_u32 s29, s29, 1024
    buffer_load_dwordx4 v[164:167], v4, s[4:7], s29 offen sc1
    ds_read_b128 v[68:71], v6 offset:39168
    s_add_u32 s29, s29, 1024
    s_waitcnt vmcnt(0) lgkmcnt(0)
    v_mfma_f32_32x32x16_bf16 v[16:31], v[48:51], v[144:147], v[16:31]
    v_mfma_f32_32x32x16_bf16 v[16:31], v[52:55], v[148:151], v[16:31]
    v_mfma_f32_32x32x16_bf16 v[16:31], v[56:59], v[152:155], v[16:31]
    v_mfma_f32_32x32x16_bf16 v[16:31], v[60:63], v[156:159], v[16:31]
    v_mfma_f32_32x32x16_bf16 v[16:31], v[64:67], v[160:163], v[16:31]
    v_mfma_f32_32x32x16_bf16 v[16:31], v[68:71], v[164:167], v[16:31]
    s_nop 7
    s_nop 7
    s_nop 7
    s_branch L_bk_39
L_rem_37:
    v_and_b32 v11, 15, v0
    s_lshl_b32 s33, s28, 4
    v_add_u32 v11, s33, v11
    v_add_u32 v12, s26, v11
    v_lshlrev_b32 v1, 2, v12
    buffer_load_dword v1, v1, s[4:7], 0 offen offset:0 sc1
    v_lshrrev_b32 v13, 5, v0
    v_bfe_u32 v14, v0, 4, 1
    v_lshlrev_b32 v15, 4, v11
    v_lshl_add_u32 v15, v14, 9, v15
    v_add_u32 v7, s31, v15
    v_add_u32 v7, 8192, v7
    v_lshl_add_u32 v15, v13, 10, v15
    v_add_u32 v4, s30, v15
    v_mul_u32_u24 v15, 2304, v13
    v_lshl_add_u32 v15, v14, 7, v15
    v_and_b32 v14, 7, v0
    v_lshl_add_u32 v15, v14, 4, v15
    v_add_u32 v5, 2048, v15
    v_add_u32 v6, 41472, v5
    v_mul_u32_u24 v12, 1152, v12
    v_lshrrev_b32 v13, 4, v0
    v_lshl_add_u32 v12, v13, 3, v12
    s_add_u32 s33, s29, 128
    v_add_u32 v12, s33, v12
    v_mov_b32 v13, 268435456
    v_cmp_gt_u32 vcc, 32, v0
    s_nop 1
    v_cndmask_b32 v8, v13, v12, vcc
    ds_read_b128 v[48:51], v5 offset:0
    ds_read_b128 v[52:55], v5 offset:4608
    ds_read_b128 v[56:59], v5 offset:9216
    ds_read_b128 v[60:63], v5 offset:13824
    ds_read_b128 v[64:67], v5 offset:18432
    ds_read_b128 v[68:71], v5 offset:23040
    ds_read_b128 v[72:75], v5 offset:27648
    ds_read_b128 v[76:79], v5 offset:32256
    ds_read_b128 v[80:83], v5 offset:36864
    ds_read_b128 v[84:87], v6 offset:0
    ds_read_b128 v[88:91], v6 offset:4608
    ds_read_b128 v[92:95], v6 offset:9216
    ds_read_b128 v[96:99], v6 offset:13824
    ds_read_b128 v[100:103], v6 offset:18432
    ds_read_b128 v[104:107], v6 offset:23040
    ds_read_b128 v[108:111], v6 offset:27648
    ds_read_b128 v[112:115], v6 offset:32256
    ds_read_b128 v[116:119], v6 offset:36864
    s_barrier
    ds_read_b128 v[32:35], v7 offset:0
    ds_read_b128 v[16:19], v7 offset:18432
    s_waitcnt lgkmcnt(0)
    s_barrier
    s_waitcnt vmcnt(1)
    buffer_store_dword v159, v9, s[4:7], s32 offen sc1
    s_waitcnt vmcnt(1) lgkmcnt(0)
    v_sub_f32 v2, 1.0, v1
    v_sub_f32 v3, 1.0, v1
    v_pk_add_f32 v[32:33], v[32:33], v[16:17]
    v_pk_add_f32 v[34:35], v[34:35], v[18:19]
    v_mul_f32 v32, v32, v1
    v_mul_f32 v33, v33, v1
    v_mul_f32 v34, v34, v1
    v_mul_f32 v35, v35, v1
    s_lshl_b32 s33, s28, 4
    v_and_b32 v11, 15, v0
    v_add_u32 v11, s33, v11
    v_lshrrev_b32 v12, 4, v0
    v_lshlrev_b32 v12, 9, v12
    v_lshl_add_u32 v12, v11, 2, v12
    v_add_u32 v10, s30, v12
    v_mov_b32 v13, 0
    s_barrier
    ds_read_b32 v144, v10 offset:0
    ds_read_b32 v145, v10 offset:128
    ds_read_b32 v146, v10 offset:256
    ds_read_b32 v147, v10 offset:384
    ds_read_b32 v148, v10 offset:2048
    ds_read_b32 v149, v10 offset:2176
    ds_read_b32 v150, v10 offset:2304
    ds_read_b32 v151, v10 offset:2432
    ds_read_b128 v[152:155], v4 offset:4096
    ds_read_b128 v[156:159], v4 offset:6144
    s_waitcnt lgkmcnt(6)
    v_mfma_f32_16x16x32_bf16 v[16:19], v[48:51], v[144:147], 0
    v_max3_u32 v13, v144, v145, v13
    v_max3_u32 v13, v146, v147, v13
    s_waitcnt lgkmcnt(2)
    v_mfma_f32_16x16x32_bf16 v[16:19], v[52:55], v[148:151], v[16:19]
    v_max3_u32 v13, v148, v149, v13
    v_max3_u32 v13, v150, v151, v13
    s_barrier
    ds_read_b128 v[160:163], v4 offset:8192
    ds_read_b128 v[164:167], v4 offset:10240
    ds_read_b128 v[144:147], v4 offset:12288
    ds_read_b128 v[148:151], v4 offset:14336
    s_waitcnt lgkmcnt(5)
    v_mfma_f32_16x16x32_bf16 v[16:19], v[56:59], v[152:155], v[16:19]
    v_max3_u32 v13, v152, v155, v13
    s_waitcnt lgkmcnt(4)
    v_mfma_f32_16x16x32_bf16 v[16:19], v[60:63], v[156:159], v[16:19]
    v_max3_u32 v13, v156, v159, v13
    s_waitcnt lgkmcnt(3)
    v_mfma_f32_16x16x32_bf16 v[16:19], v[64:67], v[160:163], v[16:19]
    v_max3_u32 v13, v160, v163, v13
    s_waitcnt lgkmcnt(2)
    v_mfma_f32_16x16x32_bf16 v[16:19], v[68:71], v[164:167], v[16:19]
    v_max3_u32 v13, v164, v167, v13
    s_barrier
    ds_read_b128 v[152:155], v4 offset:16384
    ds_read_b128 v[156:159], v4 offset:18432
    ds_read_b128 v[160:163], v4 offset:20480
    ds_read_b128 v[164:167], v4 offset:22528
    s_waitcnt lgkmcnt(5)
    v_mfma_f32_16x16x32_bf16 v[16:19], v[72:75], v[144:147], v[16:19]
    v_max3_u32 v13, v144, v147, v13
    s_waitcnt lgkmcnt(4)
    v_mfma_f32_16x16x32_bf16 v[16:19], v[76:79], v[148:151], v[16:19]
    v_max3_u32 v13, v148, v151, v13
    s_waitcnt lgkmcnt(3)
    v_mfma_f32_16x16x32_bf16 v[16:19], v[80:83], v[152:155], v[16:19]
    v_max3_u32 v13, v152, v155, v13
    s_waitcnt lgkmcnt(2)
    v_mfma_f32_16x16x32_bf16 v[16:19], v[84:87], v[156:159], v[16:19]
    v_max3_u32 v13, v156, v159, v13
    s_barrier
    ds_read_b128 v[144:147], v4 offset:24576
    ds_read_b128 v[148:151], v4 offset:26624
    ds_read_b128 v[152:155], v4 offset:28672
    s_waitcnt lgkmcnt(4)
    v_mfma_f32_16x16x32_bf16 v[16:19], v[88:91], v[160:163], v[16:19]
    v_max3_u32 v13, v160, v163, v13
    s_waitcnt lgkmcnt(3)
    v_mfma_f32_16x16x32_bf16 v[16:19], v[92:95], v[164:167], v[16:19]
    v_max3_u32 v13, v164, v167, v13
    s_waitcnt lgkmcnt(2)
    v_mfma_f32_16x16x32_bf16 v[16:19], v[96:99], v[144:147], v[16:19]
    v_max3_u32 v13, v144, v147, v13
    s_barrier
    ds_read_b128 v[156:159], v4 offset:30720
    ds_read_b128 v[160:163], v4 offset:32768
    s_waitcnt lgkmcnt(3)
    v_mfma_f32_16x16x32_bf16 v[16:19], v[100:103], v[148:151], v[16:19]
    v_max3_u32 v13, v148, v151, v13
    s_waitcnt lgkmcnt(2)
    v_mfma_f32_16x16x32_bf16 v[16:19], v[104:107], v[152:155], v[16:19]
    v_max3_u32 v13, v152, v155, v13
    s_barrier
    ds_read_b128 v[164:167], v4 offset:34816
    s_waitcnt lgkmcnt(2)
    v_mfma_f32_16x16x32_bf16 v[16:19], v[108:111], v[156:159], v[16:19]
    v_max3_u32 v13, v156, v159, v13
    s_waitcnt lgkmcnt(1)
    v_mfma_f32_16x16x32_bf16 v[16:19], v[112:115], v[160:163], v[16:19]
    v_max3_u32 v13, v160, v163, v13
    s_waitcnt lgkmcnt(0)
    v_mfma_f32_16x16x32_bf16 v[16:19], v[116:119], v[164:167], v[16:19]
    v_max3_u32 v13, v164, v167, v13
    v_cmp_eq_u32 vcc, -1, v13
    s_cmp_lg_u64 vcc, 0
    s_cbranch_scc1 L_fb_42
L_bk_43:
    s_nop 3
    v_pk_fma_f32 v[16:17], v[16:17], v[2:3], v[32:33]
    v_pk_fma_f32 v[18:19], v[18:19], v[2:3], v[34:35]
    v_cvt_pk_bf16_f32 v16, v16, v17
    v_cvt_pk_bf16_f32 v17, v18, v19
    buffer_store_dwordx2 v[16:17], v8, s[8:11], 0 offen
    s_endpgm
L_fb_42:
    s_mov_b32 s16, s54
    s_mov_b32 s17, s55
    s_mov_b32 s18, 256
    s_mov_b32 s19, 0x00020000
    v_bfe_u32 v14, v0, 3, 2
    v_lshlrev_b32 v14, 6, v14
    buffer_load_dword v15, v14, s[16:19], 0 offen sc1
    s_lshr_b32 s29, s26, 5
    s_lshl_b32 s31, s29, 3
    s_and_b32 s33, s21, 7
    s_add_u32 s31, s31, s33
    s_lshl_b32 s31, s31, 7
    s_add_u32 s31, s31, 102400
    s_mul_i32 s29, s29, 36864
    s_add_u32 s29, s29, 17047552
    v_and_b32 v12, 31, v0
    v_lshlrev_b32 v12, 2, v12
    v_subrev_u32 v4, s30, v4
    v_subrev_u32 v10, s30, v10
    s_mov_b32 s33, 0
L_fpl_44:
    buffer_load_dword v14, v12, s[4:7], s31 offen sc1
    s_add_u32 s33, s33, 1
    s_cmp_ge_u32 s33, 65536
    s_cbranch_scc1 L_fpd_45
    s_waitcnt vmcnt(0)
    v_cmp_eq_u32 vcc, v14, v15
    s_cmp_eq_u64 vcc, -1
    s_cbranch_scc0 L_fpl_44
L_fpd_45:
    s_waitcnt vmcnt(0)
    buffer_load_dword v144, v10, s[4:7], s29 offen offset:0 sc1
    buffer_load_dword v145, v10, s[4:7], s29 offen offset:128 sc1
    buffer_load_dword v146, v10, s[4:7], s29 offen offset:256 sc1
    buffer_load_dword v147, v10, s[4:7], s29 offen offset:384 sc1
    s_add_u32 s29, s29, 2048
    buffer_load_dword v148, v10, s[4:7], s29 offen offset:0 sc1
    buffer_load_dword v149, v10, s[4:7], s29 offen offset:128 sc1
    buffer_load_dword v150, v10, s[4:7], s29 offen offset:256 sc1
    buffer_load_dword v151, v10, s[4:7], s29 offen offset:384 sc1
    s_add_u32 s29, s29, 2048
    buffer_load_dwordx4 v[152:155], v4, s[4:7], s29 offen sc1
    s_add_u32 s29, s29, 2048
    buffer_load_dwordx4 v[156:159], v4, s[4:7], s29 offen sc1
    s_add_u32 s29, s29, 2048
    buffer_load_dwordx4 v[160:163], v4, s[4:7], s29 offen sc1
    s_add_u32 s29, s29, 2048
    buffer_load_dwordx4 v[164:167], v4, s[4:7], s29 offen sc1
    s_add_u32 s29, s29, 2048
    s_waitcnt vmcnt(0) lgkmcnt(0)
    v_mfma_f32_16x16x32_bf16 v[16:19], v[48:51], v[144:147], 0
    v_mfma_f32_16x16x32_bf16 v[16:19], v[52:55], v[148:151], v[16:19]
    v_mfma_f32_16x16x32_bf16 v[16:19], v[56:59], v[152:155], v[16:19]
    v_mfma_f32_16x16x32_bf16 v[16:19], v[60:63], v[156:159], v[16:19]
    v_mfma_f32_16x16x32_bf16 v[16:19], v[64:67], v[160:163], v[16:19]
    v_mfma_f32_16x16x32_bf16 v[16:19], v[68:71], v[164:167], v[16:19]
    buffer_load_dwordx4 v[144:147], v4, s[4:7], s29 offen sc1
    s_add_u32 s29, s29, 2048
    buffer_load_dwordx4 v[148:151], v4, s[4:7], s29 offen sc1
    s_add_u32 s29, s29, 2048
    buffer_load_dwordx4 v[152:155], v4, s[4:7], s29 offen sc1
    s_add_u32 s29, s29, 2048
    buffer_load_dwordx4 v[156:159], v4, s[4:7], s29 offen sc1
    s_add_u32 s29, s29, 2048
    buffer_load_dwordx4 v[160:163], v4, s[4:7], s29 offen sc1
    s_add_u32 s29, s29, 2048
    buffer_load_dwordx4 v[164:167], v4, s[4:7], s29 offen sc1
    s_add_u32 s29, s29, 2048
    s_waitcnt vmcnt(0) lgkmcnt(0)
    v_mfma_f32_16x16x32_bf16 v[16:19], v[72:75], v[144:147], v[16:19]
    v_mfma_f32_16x16x32_bf16 v[16:19], v[76:79], v[148:151], v[16:19]
    v_mfma_f32_16x16x32_bf16 v[16:19], v[80:83], v[152:155], v[16:19]
    v_mfma_f32_16x16x32_bf16 v[16:19], v[84:87], v[156:159], v[16:19]
    v_mfma_f32_16x16x32_bf16 v[16:19], v[88:91], v[160:163], v[16:19]
    v_mfma_f32_16x16x32_bf16 v[16:19], v[92:95], v[164:167], v[16:19]
    buffer_load_dwordx4 v[144:147], v4, s[4:7], s29 offen sc1
    s_add_u32 s29, s29, 2048
    buffer_load_dwordx4 v[148:151], v4, s[4:7], s29 offen sc1
    s_add_u32 s29, s29, 2048
    buffer_load_dwordx4 v[152:155], v4, s[4:7], s29 offen sc1
    s_add_u32 s29, s29, 2048
    buffer_load_dwordx4 v[156:159], v4, s[4:7], s29 offen sc1
    s_add_u32 s29, s29, 2048
    buffer_load_dwordx4 v[160:163], v4, s[4:7], s29 offen sc1
    s_add_u32 s29, s29, 2048
    buffer_load_dwordx4 v[164:167], v4, s[4:7], s29 offen sc1
    s_add_u32 s29, s29, 2048
    s_waitcnt vmcnt(0) lgkmcnt(0)
    v_mfma_f32_16x16x32_bf16 v[16:19], v[96:99], v[144:147], v[16:19]
    v_mfma_f32_16x16x32_bf16 v[16:19], v[100:103], v[148:151], v[16:19]
    v_mfma_f32_16x16x32_bf16 v[16:19], v[104:107], v[152:155], v[16:19]
    v_mfma_f32_16x16x32_bf16 v[16:19], v[108:111], v[156:159], v[16:19]
    v_mfma_f32_16x16x32_bf16 v[16:19], v[112:115], v[160:163], v[16:19]
    v_mfma_f32_16x16x32_bf16 v[16:19], v[116:119], v[164:167], v[16:19]
    s_nop 7
    s_nop 7
    s_nop 7
    s_branch L_bk_43
L_f3_kernel_slow:
    s_barrier
    v_lshlrev_b32 v1, 4, v0
    s_mul_i32 s31, s21, 155648
    s_add_u32 s31, s31, 2367488
    s_mov_b32 s26, s20
L_rl_46:
    s_mul_i32 s27, s26, 3450
    s_lshr_b32 s27, s27, 16
    s_mul_i32 s28, s27, 19
    s_sub_u32 s28, s26, s28
    s_lshl_b32 s28, s28, 10
    s_mul_i32 s29, s27, 19456
    s_add_u32 s29, s29, s28
    s_mov_b32 m0, s29
    s_add_u32 s27, s27, s22
    s_and_b32 s27, s27, 7
    s_mul_i32 s27, s27, 19456
    s_add_u32 s27, s27, s28
    s_add_u32 s27, s27, s31
    buffer_load_dwordx4 v1, s[4:7], s27 offen sc1 lds
    s_add_u32 s26, s26, 8
    s_cmp_lt_u32 s26, 114
    s_cbranch_scc1 L_rl_46
    v_add_u32 v136, 4294850560, v136
    v_add_u32 v137, 4294850560, v137
    v_add_u32 v138, 4294850560, v138
    v_add_u32 v139, 4294850560, v139
    v_add_u32 v140, 4294850560, v140
    v_add_u32 v141, 4294850560, v141
    v_mov_b32 v151, 0
    v_mov_b32 v151, 0
    v_mov_b32 v10, 0xff800000
    v_mov_b32 v11, 0xff800000
    v_mov_b32 v9, 0x3f80
    v_cmp_gt_u32 vcc, 32, v0
    v_mov_b32 v157, v9
    s_waitcnt vmcnt(0)
    s_barrier
    s_mov_b32 s34, 0
L_p1_47:
    s_lshr_b32 s26, s34, 2
    s_mul_i32 s26, s26, 19456
    s_and_b32 s27, s34, 3
    s_lshl_b32 s28, s27, 10
    s_add_u32 s44, s26, s28
    s_lshl_b32 s28, s27, 7
    s_add_u32 s45, s26, s28
    s_mul_i32 s28, s27, 1280
    s_add_u32 s46, s26, s28
    v_add_u32 v12, s44, v136
    v_add_u32 v13, s45, v137
    ds_read_b128 v[152:155], v12 offset:0
    ds_read_b32 v156, v13 offset:0
    s_waitcnt lgkmcnt(0)
    v_mfma_f32_32x32x4_2b_bf16 v[48:79], v[156:157], v[150:151], 0
    s_nop 15
    s_nop 3
    v_mfma_f32_32x32x16_bf16 v[48:63], v[152:155], v[128:131], v[48:63]
    v_mfma_f32_32x32x16_bf16 v[64:79], v[152:155], v[132:135], v[64:79]
    s_nop 10
    v_max3_f32 v1, v48, v49, v50
    v_max3_f32 v2, v51, v52, v53
    v_max3_f32 v1, v1, v54, v55
    v_max3_f32 v2, v2, v56, v57
    v_max3_f32 v1, v1, v58, v59
    v_max3_f32 v2, v2, v60, v61
    v_max3_f32 v1, v1, v62, v63
    v_max_f32 v1, v1, v2
    v_max3_f32 v3, v64, v65, v66
    v_max3_f32 v4, v67, v68, v69
    v_max3_f32 v3, v3, v70, v71
    v_max3_f32 v4, v4, v72, v73
    v_max3_f32 v3, v3, v74, v75
    v_max3_f32 v4, v4, v76, v77
    v_max3_f32 v3, v3, v78, v79
    v_max_f32 v3, v3, v4
    v_max_f32 v10, v10, v1
    v_max_f32 v11, v11, v3
    s_add_u32 s34, s34, 1
    s_cmp_lt_u32 s34, 32
    s_cbranch_scc1 L_p1_47
    v_mov_b32 v2, v10
    v_mov_b32 v4, v11
    s_nop 1
    v_permlane32_swap_b32 v10, v2
    v_permlane32_swap_b32 v11, v4
    s_nop 1
    v_max_f32 v10, v10, v2
    v_max_f32 v11, v11, v4
    v_lshlrev_b32 v1, 3, v0
    s_lshl_b32 s26, s20, 9
    s_add_u32 s26, s26, 156672
    v_add_u32 v2, s26, v1
    s_xor_b32 s27, s20, 4
    s_lshl_b32 s26, s27, 9
    s_add_u32 s26, s26, 156672
    v_add_u32 v3, s26, v1
    ds_write_b64 v2, v[10:11]
    s_waitcnt lgkmcnt(0)
    s_barrier
    ds_read_b64 v[4:5], v3
    s_waitcnt lgkmcnt(0)
    v_max_f32 v10, v10, v5
    v_max_f32 v11, v11, v4
    v_mov_b32 v16, 0
    v_mov_b32 v17, 0
    v_mov_b32 v18, 0
    v_mov_b32 v19, 0
    v_mov_b32 v20, 0
    v_mov_b32 v21, 0
    v_mov_b32 v22, 0
    v_mov_b32 v23, 0
    v_mov_b32 v24, 0
    v_mov_b32 v25, 0
    v_mov_b32 v26, 0
    v_mov_b32 v27, 0
    v_mov_b32 v28, 0
    v_mov_b32 v29, 0
    v_mov_b32 v30, 0
    v_mov_b32 v31, 0
    v_mov_b32 v32, 0
    v_mov_b32 v33, 0
    v_mov_b32 v34, 0
    v_mov_b32 v35, 0
    v_mov_b32 v36, 0
    v_mov_b32 v37, 0
    v_mov_b32 v38, 0
    v_mov_b32 v39, 0
    v_mov_b32 v40, 0
    v_mov_b32 v41, 0
    v_mov_b32 v42, 0
    v_mov_b32 v43, 0
    v_mov_b32 v44, 0
    v_mov_b32 v45, 0
    v_mov_b32 v46, 0
    v_mov_b32 v47, 0
    s_mov_b32 s34, 0
L_p2_48:
    s_lshr_b32 s26, s34, 2
    s_mul_i32 s26, s26, 19456
    s_and_b32 s27, s34, 3
    s_lshl_b32 s28, s27, 10
    s_add_u32 s44, s26, s28
    s_lshl_b32 s28, s27, 7
    s_add_u32 s45, s26, s28
    s_mul_i32 s28, s27, 1280
    s_add_u32 s46, s26, s28
    v_add_u32 v12, s44, v136
    v_add_u32 v13, s45, v137
    v_add_u32 v4, s46, v138
    v_add_u32 v5, s46, v139
    v_add_u32 v6, s46, v140
    v_add_u32 v7, s46, v141
    ds_read_b128 v[152:155], v12 offset:0
    ds_read_b32 v156, v13 offset:0
    ds_read_b64_tr_b16 v[160:161], v4
    ds_read_b64_tr_b16 v[162:163], v5
    ds_read_b64_tr_b16 v[164:165], v6
    ds_read_b64_tr_b16 v[166:167], v7
    s_waitcnt lgkmcnt(0)
    v_mfma_f32_32x32x4_2b_bf16 v[48:79], v[156:157], v[150:151], 0
    s_nop 15
    s_nop 3
    v_mfma_f32_32x32x16_bf16 v[48:63], v[152:155], v[128:131], v[48:63]
    v_mfma_f32_32x32x16_bf16 v[64:79], v[152:155], v[132:135], v[64:79]
    s_nop 10
    v_sub_f32 v48, v48, v10
    v_sub_f32 v49, v49, v10
    v_sub_f32 v50, v50, v10
    v_sub_f32 v51, v51, v10
    v_sub_f32 v52, v52, v10
    v_sub_f32 v53, v53, v10
    v_sub_f32 v54, v54, v10
    v_sub_f32 v55, v55, v10
    v_sub_f32 v56, v56, v10
    v_sub_f32 v57, v57, v10
    v_sub_f32 v58, v58, v10
    v_sub_f32 v59, v59, v10
    v_sub_f32 v60, v60, v10
    v_sub_f32 v61, v61, v10
    v_sub_f32 v62, v62, v10
    v_sub_f32 v63, v63, v10
    v_exp_f32 v48, v48
    v_exp_f32 v49, v49
    v_exp_f32 v50, v50
    v_exp_f32 v51, v51
    v_exp_f32 v52, v52
    v_exp_f32 v53, v53
    v_exp_f32 v54, v54
    v_exp_f32 v55, v55
    v_exp_f32 v56, v56
    v_exp_f32 v57, v57
    v_exp_f32 v58, v58
    v_exp_f32 v59, v59
    v_exp_f32 v60, v60
    v_exp_f32 v61, v61
    v_exp_f32 v62, v62
    v_exp_f32 v63, v63
    v_cvt_pk_bf16_f32 v80, v48, v49
    v_cvt_pk_bf16_f32 v81, v50, v51
    v_cvt_pk_bf16_f32 v82, v52, v53
    v_cvt_pk_bf16_f32 v83, v54, v55
    v_cvt_pk_bf16_f32 v84, v56, v57
    v_cvt_pk_bf16_f32 v85, v58, v59
    v_cvt_pk_bf16_f32 v86, v60, v61
    v_cvt_pk_bf16_f32 v87, v62, v63
    v_sub_f32 v64, v64, v11
    v_sub_f32 v65, v65, v11
    v_sub_f32 v66, v66, v11
    v_sub_f32 v67, v67, v11
    v_sub_f32 v68, v68, v11
    v_sub_f32 v69, v69, v11
    v_sub_f32 v70, v70, v11
    v_sub_f32 v71, v71, v11
    v_sub_f32 v72, v72, v11
    v_sub_f32 v73, v73, v11
    v_sub_f32 v74, v74, v11
    v_sub_f32 v75, v75, v11
    v_sub_f32 v76, v76, v11
    v_sub_f32 v77, v77, v11
    v_sub_f32 v78, v78, v11
    v_sub_f32 v79, v79, v11
    v_exp_f32 v64, v64
    v_exp_f32 v65, v65
    v_exp_f32 v66, v66
    v_exp_f32 v67, v67
    v_exp_f32 v68, v68
    v_exp_f32 v69, v69
    v_exp_f32 v70, v70
    v_exp_f32 v71, v71
    v_exp_f32 v72, v72
    v_exp_f32 v73, v73
    v_exp_f32 v74, v74
    v_exp_f32 v75, v75
    v_exp_f32 v76, v76
    v_exp_f32 v77, v77
    v_exp_f32 v78, v78
    v_exp_f32 v79, v79
    v_cvt_pk_bf16_f32 v88, v64, v65
    v_cvt_pk_bf16_f32 v89, v66, v67
    v_cvt_pk_bf16_f32 v90, v68, v69
    v_cvt_pk_bf16_f32 v91, v70, v71
    v_cvt_pk_bf16_f32 v92, v72, v73
    v_cvt_pk_bf16_f32 v93, v74, v75
    v_cvt_pk_bf16_f32 v94, v76, v77
    v_cvt_pk_bf16_f32 v95, v78, v79
    v_mfma_f32_32x32x16_bf16 v[16:31], v[160:163], v[80:83], v[16:31]
    v_mfma_f32_32x32x16_bf16 v[32:47], v[160:163], v[88:91], v[32:47]
    v_mfma_f32_32x32x16_bf16 v[16:31], v[164:167], v[84:87], v[16:31]
    v_mfma_f32_32x32x16_bf16 v[32:47], v[164:167], v[92:95], v[32:47]
    s_add_u32 s34, s34, 1
    s_cmp_lt_u32 s34, 32
    s_cbranch_scc1 L_p2_48
    s_nop 7
    s_nop 7
    s_barrier
    ds_write_b128 v144, v[32:35] offset:0
    ds_write_b128 v144, v[36:39] offset:1024
    ds_write_b128 v144, v[40:43] offset:2048
    s_waitcnt lgkmcnt(0)
    s_barrier
    ds_read_b128 v[32:35], v145 offset:0
    ds_read_b128 v[36:39], v145 offset:1024
    ds_read_b128 v[40:43], v145 offset:2048
    s_waitcnt lgkmcnt(0)
    v_add_f32 v26, v26, v42
    v_pk_add_f32 v[16:17], v[16:17], v[32:33]
    v_pk_add_f32 v[18:19], v[18:19], v[34:35]
    v_pk_add_f32 v[20:21], v[20:21], v[36:37]
    v_pk_add_f32 v[22:23], v[22:23], v[38:39]
    v_pk_add_f32 v[24:25], v[24:25], v[40:41]
    v_mov_b32 v1, v26
    s_nop 1
    v_permlane32_swap_b32 v26, v1
    v_rcp_f32 v26, v26
    s_nop 0
    v_mul_f32 v16, v16, v26
    v_mul_f32 v17, v17, v26
    v_mul_f32 v18, v18, v26
    v_mul_f32 v19, v19, v26
    v_mul_f32 v20, v20, v26
    v_mul_f32 v21, v21, v26
    v_mul_f32 v22, v22, v26
    v_mul_f32 v23, v23, v26
    v_mul_f32 v24, v24, v26
    v_mul_f32 v25, v25, v26
    v_cvt_pk_bf16_f32 v16, v16, v17
    v_cvt_pk_bf16_f32 v17, v18, v19
    v_cvt_pk_bf16_f32 v18, v20, v21
    v_cvt_pk_bf16_f32 v19, v22, v23
    v_cvt_pk_bf16_f32 v20, v24, v25
    s_branch L_f3_kernel_tail
L_f3_kernel_end:
    s_endpgm

.section .rodata,"a"
.p2align 6
.amdhsa_kernel f3_kernel
  .amdhsa_next_free_vgpr 168
  .amdhsa_next_free_sgpr 102
  .amdhsa_accum_offset 168
  .amdhsa_group_segment_fixed_size 0
  .amdhsa_kernarg_size 80
  .amdhsa_user_sgpr_count 2
  .amdhsa_user_sgpr_kernarg_segment_ptr 1
  .amdhsa_system_sgpr_workgroup_id_x 1
.end_amdhsa_kernel
```
